```python
import torch

def _softmax(x, axis=-1):
    return torch.softmax(x, dim=axis)
def _gelu(x):
    return torch.nn.functional.gelu(x, approximate="tanh")
def _silu(x):
    return torch.nn.functional.silu(x)
def _sigmoid(x):
    return torch.sigmoid(x)
def _layernorm(x, axis=-1, eps=1e-5):
    m = x.mean(dim=axis, keepdim=True)
    v = x.var(dim=axis, keepdim=True, unbiased=False)
    return (x - m) / torch.sqrt(v + eps)
def _scatter_add(tgt, idx, src, axis=0):
    return tgt.clone().index_add_(axis, idx, src)
def _segment_sum(src, seg, n):
    out = torch.zeros((n,) + src.shape[1:], dtype=src.dtype)
    return out.index_add_(0, seg, src)
def _pad(x, pw):
    flat = tuple(v for pair in reversed(pw) for v in pair)
    return torch.nn.functional.pad(x, flat)

kernel_name = 'gather_scatter__molecular_angular_gemnet__graph'

def setup_inputs():

    _w = (lambda a: (lambda t: t.to(torch.bfloat16) if t.is_floating_point() else t)(torch.as_tensor(a)))
    N, deg, De, L = 10000, 16, 16, 2
    E = N * deg
    T = E * deg
    NR = 8
    dist = torch.rand(E).to(float)
    angle = (torch.rand(T) * torch.pi).to(float)
    centers = torch.linspace(0.0, 1.0, NR).to(float)
    ang_freq = torch.arange(1, L + 1).to(float)
    return {
        "m": _w((lambda *s: torch.randn(*s, dtype=torch.bfloat16) * 0.05)(E, De)),
        "idx_in": _w((lambda lo, hi, *s: torch.randint(lo, hi, s))(0, E, T).to(torch.int64)),
        "idx_out": _w((lambda lo, hi, *s: torch.randint(lo, hi, s))(0, E, T).to(torch.int64)),
        "dist": _w(dist),
        "angle": _w(angle),
        "centers": _w(centers),
        "ang_freq": _w(ang_freq),
        "w_rbf": _w((lambda *s: torch.randn(*s, dtype=torch.bfloat16) * 0.2)(NR, De)),
        "w_sbf": _w((lambda *s: torch.randn(*s, dtype=torch.bfloat16) * 0.2)(NR * L, De)),
        "w_down": _w((lambda *s: torch.randn(*s, dtype=torch.bfloat16) * 0.2)(De, De)),
        "w_up": _w((lambda *s: torch.randn(*s, dtype=torch.bfloat16) * 0.2)(De, De)),
    }

def reference(m, idx_in, idx_out, dist, angle, centers, ang_freq, w_rbf, w_sbf, w_down, w_up):
    E, De = m.shape[0], m.shape[1]
    NR = centers.shape[0]
    L = ang_freq.shape[0]
    rbf = torch.exp(-10.0 * (dist[:, None] - centers[None, :]) ** 2)
    cbf = torch.cos(ang_freq[None, :] * angle[:, None])
    rbf_t = rbf[idx_out]
    sbf = torch.reshape(rbf_t[:, :, None] * cbf[:, None, :], (-1, NR * L))
    x = (m[idx_in] @ w_down) * (sbf @ w_sbf)
    agg = _segment_sum(x, idx_out, E)
    return m + (agg @ w_up) * (rbf @ w_rbf)
```

```asm
; @launch kernel=part_kernel grid=(256,1,1) block=(512,1,1) lds=83968
; @launch kernel=gath_kernel grid=(256,1,1) block=(640,1,1) lds=120656
.amdgcn_target "amdgcn-amd-amdhsa--gfx950"
.text
.globl part_kernel
.p2align 8
.type part_kernel,@function
part_kernel:
s_cmp_ge_u32 s2, 256
s_cbranch_scc1 P_EXIT
s_load_dwordx4 s[4:7], s[0:1], 8
s_load_dwordx2 s[8:9], s[0:1], 32
s_load_dwordx2 s[10:11], s[0:1], 104
s_load_dwordx8 s[40:47], s[0:1], 56
v_lshlrev_b32 v1, 4, v0
v_lshlrev_b32 v2, 3, v0
v_lshlrev_b32 v3, 2, v0
v_mov_b32 v4, 0
v_mov_b32 v5, 1
v_readfirstlane_b32 s35, v0
ds_write_b32 v3, v4
v_cmp_gt_u32 vcc, 452, v0
s_mul_i32 s28, s2, 40000
s_mul_i32 s29, s2, 20000
s_mov_b64 s[36:37], vcc
s_waitcnt lgkmcnt(0)
s_mov_b32 s12, s4
s_mov_b32 s13, s5
s_mov_b32 s14, 10240000
s_mov_b32 s15, 0x00020000
s_mov_b32 s16, s6
s_mov_b32 s17, s7
s_mov_b32 s18, 10240000
s_mov_b32 s19, 0x00020000
s_mov_b32 s20, s8
s_mov_b32 s21, s9
s_mov_b32 s22, 5120000
s_mov_b32 s23, 0x00020000
s_mov_b32 s24, s10
s_mov_b32 s25, s11
s_mov_b32 s26, 16258048
s_mov_b32 s27, 0x00020000
v_mov_b32 v136, 0
s_cmp_lg_u32 s35, 448
s_cbranch_scc1 P_NOPREP
s_cmp_ge_u32 s2, 5
s_cbranch_scc1 P_NOPREP
v_and_b32 v8, 3, v0
v_bfe_u32 v9, v0, 2, 1
v_lshl_add_u32 v8, v9, 3, v8
v_bfe_u32 v9, v0, 3, 1
v_lshl_add_u32 v8, v9, 2, v8
v_lshlrev_b32 v8, 1, v8
v_bfe_u32 v9, v0, 4, 1
v_bfe_u32 v13, v0, 5, 1
v_xor_b32 v14, 1, v9
v_lshl_add_u32 v15, v13, 8, v8
v_lshl_add_u32 v10, v9, 20, v15
v_lshl_add_u32 v11, v14, 20, v15
v_lshl_add_u32 v12, v9, 5, v8
v_lshl_add_u32 v12, v13, 20, v12
s_cmp_lg_u32 s2, 0
s_cbranch_scc1 P_IM1
s_mov_b32 s48, s44
s_mov_b32 s49, s45
s_mov_b32 s50, 512
s_mov_b32 s51, 0x00020000
buffer_load_ushort v128, v10, s[48:51], 0 offen offset:0
buffer_load_ushort v129, v10, s[48:51], 0 offen offset:32
buffer_load_ushort v130, v10, s[48:51], 0 offen offset:64
buffer_load_ushort v131, v10, s[48:51], 0 offen offset:96
buffer_load_ushort v132, v10, s[48:51], 0 offen offset:128
buffer_load_ushort v133, v10, s[48:51], 0 offen offset:160
buffer_load_ushort v134, v10, s[48:51], 0 offen offset:192
buffer_load_ushort v135, v10, s[48:51], 0 offen offset:224
s_branch P_NOPREP
P_IM1:
s_cmp_lg_u32 s2, 1
s_cbranch_scc1 P_IM2
s_mov_b32 s48, s44
s_mov_b32 s49, s45
s_mov_b32 s50, 512
s_mov_b32 s51, 0x00020000
buffer_load_ushort v128, v11, s[48:51], 0 offen offset:0
buffer_load_ushort v129, v11, s[48:51], 0 offen offset:32
buffer_load_ushort v130, v11, s[48:51], 0 offen offset:64
buffer_load_ushort v131, v11, s[48:51], 0 offen offset:96
buffer_load_ushort v132, v11, s[48:51], 0 offen offset:128
buffer_load_ushort v133, v11, s[48:51], 0 offen offset:160
buffer_load_ushort v134, v11, s[48:51], 0 offen offset:192
buffer_load_ushort v135, v11, s[48:51], 0 offen offset:224
s_branch P_NOPREP
P_IM2:
s_cmp_lg_u32 s2, 2
s_cbranch_scc1 P_IM3
s_mov_b32 s48, s42
s_mov_b32 s49, s43
s_mov_b32 s50, 512
s_mov_b32 s51, 0x00020000
buffer_load_ushort v128, v12, s[48:51], 0 offen offset:0
buffer_load_ushort v129, v12, s[48:51], 0 offen offset:64
buffer_load_ushort v130, v12, s[48:51], 0 offen offset:128
buffer_load_ushort v131, v12, s[48:51], 0 offen offset:192
buffer_load_ushort v132, v12, s[48:51], 0 offen offset:256
buffer_load_ushort v133, v12, s[48:51], 0 offen offset:320
buffer_load_ushort v134, v12, s[48:51], 0 offen offset:384
buffer_load_ushort v135, v12, s[48:51], 0 offen offset:448
s_branch P_NOPREP
P_IM3:
s_cmp_lg_u32 s2, 3
s_cbranch_scc1 P_IM4
s_mov_b32 s48, s46
s_mov_b32 s49, s47
s_mov_b32 s50, 512
s_mov_b32 s51, 0x00020000
buffer_load_ushort v128, v10, s[48:51], 0 offen offset:0
buffer_load_ushort v129, v10, s[48:51], 0 offen offset:32
buffer_load_ushort v130, v10, s[48:51], 0 offen offset:64
buffer_load_ushort v131, v10, s[48:51], 0 offen offset:96
buffer_load_ushort v132, v10, s[48:51], 0 offen offset:128
buffer_load_ushort v133, v10, s[48:51], 0 offen offset:160
buffer_load_ushort v134, v10, s[48:51], 0 offen offset:192
buffer_load_ushort v135, v10, s[48:51], 0 offen offset:224
s_branch P_NOPREP
P_IM4:
s_mov_b32 s48, s40
s_mov_b32 s49, s41
s_mov_b32 s50, 256
s_mov_b32 s51, 0x00020000
buffer_load_ushort v128, v11, s[48:51], 0 offen offset:0
buffer_load_ushort v129, v11, s[48:51], 0 offen offset:32
buffer_load_ushort v130, v11, s[48:51], 0 offen offset:64
buffer_load_ushort v131, v11, s[48:51], 0 offen offset:96
buffer_load_ushort v132, v11, s[48:51], 0 offen offset:128
buffer_load_ushort v133, v11, s[48:51], 0 offen offset:160
buffer_load_ushort v134, v11, s[48:51], 0 offen offset:192
buffer_load_ushort v135, v11, s[48:51], 0 offen offset:224
P_NOPREP:
s_add_u32 s30, s28, 0
buffer_load_dwordx4 v[8:11], v1, s[16:19], s30 offen nt
s_add_u32 s30, s28, 8192
buffer_load_dwordx4 v[12:15], v1, s[16:19], s30 offen nt
s_add_u32 s30, s28, 16384
buffer_load_dwordx4 v[16:19], v1, s[16:19], s30 offen nt
s_add_u32 s30, s28, 24576
buffer_load_dwordx4 v[20:23], v1, s[16:19], s30 offen nt
s_mov_b64 exec, s[36:37]
s_add_u32 s30, s28, 32768
buffer_load_dwordx4 v[24:27], v1, s[16:19], s30 offen nt
s_mov_b64 exec, -1
s_mov_b32 s31, 6871948
s_mov_b32 s32, 107374
s_mov_b32 s33, -625
s_movk_i32 s34, 132
s_movk_i32 s39, 84
s_barrier
s_waitcnt vmcnt(4)
s_add_u32 s30, s29, 0
buffer_load_dwordx2 v[48:49], v2, s[20:23], s30 offen nt
s_add_u32 s30, s28, 0
buffer_load_dwordx4 v[28:31], v1, s[12:15], s30 offen nt
v_mul_hi_u32_u24 v80, s31, v8
v_lshlrev_b32 v80, 2, v80
ds_add_rtn_u32 v60, v80, v5
v_mul_hi_u32_u24 v81, s31, v9
v_lshlrev_b32 v81, 2, v81
ds_add_rtn_u32 v61, v81, v5
v_mul_hi_u32_u24 v82, s31, v10
v_lshlrev_b32 v82, 2, v82
ds_add_rtn_u32 v62, v82, v5
v_mul_hi_u32_u24 v83, s31, v11
v_lshlrev_b32 v83, 2, v83
ds_add_rtn_u32 v63, v83, v5
s_waitcnt vmcnt(5)
s_add_u32 s30, s29, 4096
buffer_load_dwordx2 v[50:51], v2, s[20:23], s30 offen nt
s_add_u32 s30, s28, 8192
buffer_load_dwordx4 v[32:35], v1, s[12:15], s30 offen nt
v_mul_hi_u32_u24 v84, s31, v12
v_lshlrev_b32 v84, 2, v84
ds_add_rtn_u32 v64, v84, v5
v_mul_hi_u32_u24 v85, s31, v13
v_lshlrev_b32 v85, 2, v85
ds_add_rtn_u32 v65, v85, v5
v_mul_hi_u32_u24 v86, s31, v14
v_lshlrev_b32 v86, 2, v86
ds_add_rtn_u32 v66, v86, v5
v_mul_hi_u32_u24 v87, s31, v15
v_lshlrev_b32 v87, 2, v87
ds_add_rtn_u32 v67, v87, v5
s_waitcnt vmcnt(6)
s_add_u32 s30, s29, 8192
buffer_load_dwordx2 v[52:53], v2, s[20:23], s30 offen nt
s_add_u32 s30, s28, 16384
buffer_load_dwordx4 v[36:39], v1, s[12:15], s30 offen nt
v_mul_hi_u32_u24 v88, s31, v16
v_lshlrev_b32 v88, 2, v88
ds_add_rtn_u32 v68, v88, v5
v_mul_hi_u32_u24 v89, s31, v17
v_lshlrev_b32 v89, 2, v89
ds_add_rtn_u32 v69, v89, v5
v_mul_hi_u32_u24 v90, s31, v18
v_lshlrev_b32 v90, 2, v90
ds_add_rtn_u32 v70, v90, v5
v_mul_hi_u32_u24 v91, s31, v19
v_lshlrev_b32 v91, 2, v91
ds_add_rtn_u32 v71, v91, v5
s_waitcnt vmcnt(7)
s_add_u32 s30, s29, 12288
buffer_load_dwordx2 v[54:55], v2, s[20:23], s30 offen nt
s_add_u32 s30, s28, 24576
buffer_load_dwordx4 v[40:43], v1, s[12:15], s30 offen nt
v_mul_hi_u32_u24 v92, s31, v20
v_lshlrev_b32 v92, 2, v92
ds_add_rtn_u32 v72, v92, v5
v_mul_hi_u32_u24 v93, s31, v21
v_lshlrev_b32 v93, 2, v93
ds_add_rtn_u32 v73, v93, v5
v_mul_hi_u32_u24 v94, s31, v22
v_lshlrev_b32 v94, 2, v94
ds_add_rtn_u32 v74, v94, v5
v_mul_hi_u32_u24 v95, s31, v23
v_lshlrev_b32 v95, 2, v95
ds_add_rtn_u32 v75, v95, v5
s_waitcnt vmcnt(8)
s_mov_b64 exec, s[36:37]
s_add_u32 s30, s29, 16384
buffer_load_dwordx2 v[56:57], v2, s[20:23], s30 offen nt
s_add_u32 s30, s28, 32768
buffer_load_dwordx4 v[44:47], v1, s[12:15], s30 offen nt
s_mov_b64 exec, -1
s_mov_b64 exec, s[36:37]
v_mul_hi_u32_u24 v96, s31, v24
v_lshlrev_b32 v96, 2, v96
ds_add_rtn_u32 v76, v96, v5
v_mul_hi_u32_u24 v97, s31, v25
v_lshlrev_b32 v97, 2, v97
ds_add_rtn_u32 v77, v97, v5
v_mul_hi_u32_u24 v98, s31, v26
v_lshlrev_b32 v98, 2, v98
ds_add_rtn_u32 v78, v98, v5
v_mul_hi_u32_u24 v99, s31, v27
v_lshlrev_b32 v99, 2, v99
ds_add_rtn_u32 v79, v99, v5
s_mov_b64 exec, -1
v_and_b32 v6, 63, v0
v_lshlrev_b32 v6, 4, v6
s_waitcnt lgkmcnt(0)
s_barrier
ds_read_b128 v[100:103], v6
s_waitcnt lgkmcnt(0)
v_add_u32 v104, 1, v100
v_lshrrev_b32 v104, 1, v104
v_add_u32 v105, 1, v101
v_lshrrev_b32 v105, 1, v105
v_add_u32 v106, 1, v102
v_lshrrev_b32 v106, 1, v106
v_add_u32 v107, 1, v103
v_lshrrev_b32 v107, 1, v107
v_add_u32 v109, v104, v105
v_add_u32 v110, v109, v106
v_add_u32 v7, v110, v107
v_mov_b32 v111, v7
s_nop 1
v_add_u32_dpp v7, v7, v7 row_shr:1 row_mask:0xf bank_mask:0xf bound_ctrl:0
s_nop 1
v_add_u32_dpp v7, v7, v7 row_shr:2 row_mask:0xf bank_mask:0xf bound_ctrl:0
s_nop 1
v_add_u32_dpp v7, v7, v7 row_shr:4 row_mask:0xf bank_mask:0xf bound_ctrl:0
s_nop 1
v_add_u32_dpp v7, v7, v7 row_shr:8 row_mask:0xf bank_mask:0xf bound_ctrl:0
s_nop 1
v_add_u32_dpp v7, v7, v7 row_bcast:15 row_mask:0xa bank_mask:0xf
s_nop 1
v_add_u32_dpp v7, v7, v7 row_bcast:31 row_mask:0xc bank_mask:0xf
v_sub_u32 v108, v7, v111
v_add_u32 v111, v108, v110
v_add_u32 v110, v108, v109
v_add_u32 v109, v108, v104
v_mul_u32_u24 v112, 12, v108
v_mul_u32_u24 v113, 12, v109
v_mul_u32_u24 v114, 12, v110
v_mul_u32_u24 v115, 12, v111
ds_write_b128 v6, v[112:115] offset:1024
s_cmp_lg_u32 s35, 0
s_cbranch_scc1 P_NOTW0
v_lshrrev_b32 v7, 2, v112
v_lshl_or_b32 v128, v104, 16, v7
v_lshrrev_b32 v7, 2, v113
v_lshl_or_b32 v129, v105, 16, v7
v_lshrrev_b32 v7, 2, v114
v_lshl_or_b32 v130, v106, 16, v7
v_lshrrev_b32 v7, 2, v115
v_lshl_or_b32 v131, v107, 16, v7
s_lshl_b32 s30, s2, 10
s_add_u32 s30, s30, 15990784
buffer_store_dwordx4 v[128:131], v6, s[24:27], s30 offen
v_mov_b32 v120, 2560
v_mov_b32 v121, -14
v_and_b32 v122, 1, v100
v_cmp_eq_u32 vcc, 1, v122
v_mad_u32_u24 v122, v100, 6, v112
s_nop 0
v_cndmask_b32 v122, v121, v122, vcc
v_add_u32 v122, 2066, v122
ds_write_b32 v122, v120
v_and_b32 v122, 1, v101
v_cmp_eq_u32 vcc, 1, v122
v_mad_u32_u24 v122, v101, 6, v113
s_nop 0
v_cndmask_b32 v122, v121, v122, vcc
v_add_u32 v122, 2066, v122
ds_write_b32 v122, v120
v_and_b32 v122, 1, v102
v_cmp_eq_u32 vcc, 1, v122
v_mad_u32_u24 v122, v102, 6, v114
s_nop 0
v_cndmask_b32 v122, v121, v122, vcc
v_add_u32 v122, 2066, v122
ds_write_b32 v122, v120
v_and_b32 v122, 1, v103
v_cmp_eq_u32 vcc, 1, v122
v_mad_u32_u24 v122, v103, 6, v115
s_nop 0
v_cndmask_b32 v122, v121, v122, vcc
v_add_u32 v122, 2066, v122
ds_write_b32 v122, v120
P_NOTW0:
ds_read_b32 v100, v80 offset:1024
ds_read_b32 v101, v81 offset:1024
ds_read_b32 v102, v82 offset:1024
ds_read_b32 v103, v83 offset:1024
ds_read_b32 v104, v84 offset:1024
ds_read_b32 v105, v85 offset:1024
ds_read_b32 v106, v86 offset:1024
ds_read_b32 v107, v87 offset:1024
ds_read_b32 v108, v88 offset:1024
ds_read_b32 v109, v89 offset:1024
ds_read_b32 v110, v90 offset:1024
ds_read_b32 v111, v91 offset:1024
ds_read_b32 v112, v92 offset:1024
ds_read_b32 v113, v93 offset:1024
ds_read_b32 v114, v94 offset:1024
ds_read_b32 v115, v95 offset:1024
s_mov_b64 exec, s[36:37]
ds_read_b32 v116, v96 offset:1024
ds_read_b32 v117, v97 offset:1024
ds_read_b32 v118, v98 offset:1024
ds_read_b32 v119, v99 offset:1024
s_mov_b64 exec, -1
s_waitcnt vmcnt(8)
v_mul_hi_u32_u24 v6, s32, v28
v_lshl_add_u32 v6, v8, 2, v6
v_mad_i32_i24 v6, v80, s33, v6
v_lshl_add_u32 v28, v28, 14, v6
s_waitcnt lgkmcnt(0)
v_mad_u32_u24 v6, v60, 6, v100
v_and_b32 v7, 2, v6
v_add_u32 v120, v7, v6
v_mad_i32_i24 v121, v7, -2, v6
ds_write_b32 v120, v28 offset:2064
ds_write_b16 v121, v48 offset:2068
v_mul_hi_u32_u24 v6, s32, v29
v_lshl_add_u32 v6, v9, 2, v6
v_mad_i32_i24 v6, v81, s33, v6
v_lshl_add_u32 v29, v29, 14, v6
v_mad_u32_u24 v6, v61, 6, v101
v_and_b32 v7, 2, v6
v_add_u32 v122, v7, v6
v_mad_i32_i24 v123, v7, -2, v6
ds_write_b32 v122, v29 offset:2064
ds_write_b16_d16_hi v123, v48 offset:2068
v_mul_hi_u32_u24 v6, s32, v30
v_lshl_add_u32 v6, v10, 2, v6
v_mad_i32_i24 v6, v82, s33, v6
v_lshl_add_u32 v30, v30, 14, v6
v_mad_u32_u24 v6, v62, 6, v102
v_and_b32 v7, 2, v6
v_add_u32 v124, v7, v6
v_mad_i32_i24 v125, v7, -2, v6
ds_write_b32 v124, v30 offset:2064
ds_write_b16 v125, v49 offset:2068
v_mul_hi_u32_u24 v6, s32, v31
v_lshl_add_u32 v6, v11, 2, v6
v_mad_i32_i24 v6, v83, s33, v6
v_lshl_add_u32 v31, v31, 14, v6
v_mad_u32_u24 v6, v63, 6, v103
v_and_b32 v7, 2, v6
v_add_u32 v126, v7, v6
v_mad_i32_i24 v127, v7, -2, v6
ds_write_b32 v126, v31 offset:2064
ds_write_b16_d16_hi v127, v49 offset:2068
s_waitcnt vmcnt(6)
v_mul_hi_u32_u24 v6, s32, v32
v_lshl_add_u32 v6, v12, 2, v6
v_mad_i32_i24 v6, v84, s33, v6
v_lshl_add_u32 v32, v32, 14, v6
v_mad_u32_u24 v6, v64, 6, v104
v_and_b32 v7, 2, v6
v_add_u32 v120, v7, v6
v_mad_i32_i24 v121, v7, -2, v6
ds_write_b32 v120, v32 offset:2064
ds_write_b16 v121, v50 offset:2068
v_mul_hi_u32_u24 v6, s32, v33
v_lshl_add_u32 v6, v13, 2, v6
v_mad_i32_i24 v6, v85, s33, v6
v_lshl_add_u32 v33, v33, 14, v6
v_mad_u32_u24 v6, v65, 6, v105
v_and_b32 v7, 2, v6
v_add_u32 v122, v7, v6
v_mad_i32_i24 v123, v7, -2, v6
ds_write_b32 v122, v33 offset:2064
ds_write_b16_d16_hi v123, v50 offset:2068
v_mul_hi_u32_u24 v6, s32, v34
v_lshl_add_u32 v6, v14, 2, v6
v_mad_i32_i24 v6, v86, s33, v6
v_lshl_add_u32 v34, v34, 14, v6
v_mad_u32_u24 v6, v66, 6, v106
v_and_b32 v7, 2, v6
v_add_u32 v124, v7, v6
v_mad_i32_i24 v125, v7, -2, v6
ds_write_b32 v124, v34 offset:2064
ds_write_b16 v125, v51 offset:2068
v_mul_hi_u32_u24 v6, s32, v35
v_lshl_add_u32 v6, v15, 2, v6
v_mad_i32_i24 v6, v87, s33, v6
v_lshl_add_u32 v35, v35, 14, v6
v_mad_u32_u24 v6, v67, 6, v107
v_and_b32 v7, 2, v6
v_add_u32 v126, v7, v6
v_mad_i32_i24 v127, v7, -2, v6
ds_write_b32 v126, v35 offset:2064
ds_write_b16_d16_hi v127, v51 offset:2068
s_waitcnt vmcnt(4)
v_mul_hi_u32_u24 v6, s32, v36
v_lshl_add_u32 v6, v16, 2, v6
v_mad_i32_i24 v6, v88, s33, v6
v_lshl_add_u32 v36, v36, 14, v6
v_mad_u32_u24 v6, v68, 6, v108
v_and_b32 v7, 2, v6
v_add_u32 v120, v7, v6
v_mad_i32_i24 v121, v7, -2, v6
ds_write_b32 v120, v36 offset:2064
ds_write_b16 v121, v52 offset:2068
v_mul_hi_u32_u24 v6, s32, v37
v_lshl_add_u32 v6, v17, 2, v6
v_mad_i32_i24 v6, v89, s33, v6
v_lshl_add_u32 v37, v37, 14, v6
v_mad_u32_u24 v6, v69, 6, v109
v_and_b32 v7, 2, v6
v_add_u32 v122, v7, v6
v_mad_i32_i24 v123, v7, -2, v6
ds_write_b32 v122, v37 offset:2064
ds_write_b16_d16_hi v123, v52 offset:2068
v_mul_hi_u32_u24 v6, s32, v38
v_lshl_add_u32 v6, v18, 2, v6
v_mad_i32_i24 v6, v90, s33, v6
v_lshl_add_u32 v38, v38, 14, v6
v_mad_u32_u24 v6, v70, 6, v110
v_and_b32 v7, 2, v6
v_add_u32 v124, v7, v6
v_mad_i32_i24 v125, v7, -2, v6
ds_write_b32 v124, v38 offset:2064
ds_write_b16 v125, v53 offset:2068
v_mul_hi_u32_u24 v6, s32, v39
v_lshl_add_u32 v6, v19, 2, v6
v_mad_i32_i24 v6, v91, s33, v6
v_lshl_add_u32 v39, v39, 14, v6
v_mad_u32_u24 v6, v71, 6, v111
v_and_b32 v7, 2, v6
v_add_u32 v126, v7, v6
v_mad_i32_i24 v127, v7, -2, v6
ds_write_b32 v126, v39 offset:2064
ds_write_b16_d16_hi v127, v53 offset:2068
s_waitcnt vmcnt(2)
v_mul_hi_u32_u24 v6, s32, v40
v_lshl_add_u32 v6, v20, 2, v6
v_mad_i32_i24 v6, v92, s33, v6
v_lshl_add_u32 v40, v40, 14, v6
v_mad_u32_u24 v6, v72, 6, v112
v_and_b32 v7, 2, v6
v_add_u32 v120, v7, v6
v_mad_i32_i24 v121, v7, -2, v6
ds_write_b32 v120, v40 offset:2064
ds_write_b16 v121, v54 offset:2068
v_mul_hi_u32_u24 v6, s32, v41
v_lshl_add_u32 v6, v21, 2, v6
v_mad_i32_i24 v6, v93, s33, v6
v_lshl_add_u32 v41, v41, 14, v6
v_mad_u32_u24 v6, v73, 6, v113
v_and_b32 v7, 2, v6
v_add_u32 v122, v7, v6
v_mad_i32_i24 v123, v7, -2, v6
ds_write_b32 v122, v41 offset:2064
ds_write_b16_d16_hi v123, v54 offset:2068
v_mul_hi_u32_u24 v6, s32, v42
v_lshl_add_u32 v6, v22, 2, v6
v_mad_i32_i24 v6, v94, s33, v6
v_lshl_add_u32 v42, v42, 14, v6
v_mad_u32_u24 v6, v74, 6, v114
v_and_b32 v7, 2, v6
v_add_u32 v124, v7, v6
v_mad_i32_i24 v125, v7, -2, v6
ds_write_b32 v124, v42 offset:2064
ds_write_b16 v125, v55 offset:2068
v_mul_hi_u32_u24 v6, s32, v43
v_lshl_add_u32 v6, v23, 2, v6
v_mad_i32_i24 v6, v95, s33, v6
v_lshl_add_u32 v43, v43, 14, v6
v_mad_u32_u24 v6, v75, 6, v115
v_and_b32 v7, 2, v6
v_add_u32 v126, v7, v6
v_mad_i32_i24 v127, v7, -2, v6
ds_write_b32 v126, v43 offset:2064
ds_write_b16_d16_hi v127, v55 offset:2068
s_waitcnt vmcnt(0)
s_mov_b64 exec, s[36:37]
v_mul_hi_u32_u24 v6, s32, v44
v_lshl_add_u32 v6, v24, 2, v6
v_mad_i32_i24 v6, v96, s33, v6
v_lshl_add_u32 v44, v44, 14, v6
v_mad_u32_u24 v6, v76, 6, v116
v_and_b32 v7, 2, v6
v_add_u32 v120, v7, v6
v_mad_i32_i24 v121, v7, -2, v6
ds_write_b32 v120, v44 offset:2064
ds_write_b16 v121, v56 offset:2068
v_mul_hi_u32_u24 v6, s32, v45
v_lshl_add_u32 v6, v25, 2, v6
v_mad_i32_i24 v6, v97, s33, v6
v_lshl_add_u32 v45, v45, 14, v6
v_mad_u32_u24 v6, v77, 6, v117
v_and_b32 v7, 2, v6
v_add_u32 v122, v7, v6
v_mad_i32_i24 v123, v7, -2, v6
ds_write_b32 v122, v45 offset:2064
ds_write_b16_d16_hi v123, v56 offset:2068
v_mul_hi_u32_u24 v6, s32, v46
v_lshl_add_u32 v6, v26, 2, v6
v_mad_i32_i24 v6, v98, s33, v6
v_lshl_add_u32 v46, v46, 14, v6
v_mad_u32_u24 v6, v78, 6, v118
v_and_b32 v7, 2, v6
v_add_u32 v124, v7, v6
v_mad_i32_i24 v125, v7, -2, v6
ds_write_b32 v124, v46 offset:2064
ds_write_b16 v125, v57 offset:2068
v_mul_hi_u32_u24 v6, s32, v47
v_lshl_add_u32 v6, v27, 2, v6
v_mad_i32_i24 v6, v99, s33, v6
v_lshl_add_u32 v47, v47, 14, v6
v_mad_u32_u24 v6, v79, 6, v119
v_and_b32 v7, 2, v6
v_add_u32 v126, v7, v6
v_mad_i32_i24 v127, v7, -2, v6
ds_write_b32 v126, v47 offset:2064
ds_write_b16_d16_hi v127, v57 offset:2068
s_mov_b64 exec, -1
s_mul_i32 s28, s2, 62464
s_waitcnt lgkmcnt(0)
s_barrier
ds_read_b128 v[8:11], v1 offset:2064
ds_read_b128 v[12:15], v1 offset:10256
ds_read_b128 v[16:19], v1 offset:18448
ds_read_b128 v[20:23], v1 offset:26640
ds_read_b128 v[24:27], v1 offset:34832
ds_read_b128 v[28:31], v1 offset:43024
ds_read_b128 v[32:35], v1 offset:51216
s_add_u32 s30, s28, 0
s_waitcnt lgkmcnt(6)
buffer_store_dwordx4 v[8:11], v1, s[24:27], s30 offen sc1
s_add_u32 s30, s28, 8192
s_waitcnt lgkmcnt(5)
buffer_store_dwordx4 v[12:15], v1, s[24:27], s30 offen sc1
s_add_u32 s30, s28, 16384
s_waitcnt lgkmcnt(4)
buffer_store_dwordx4 v[16:19], v1, s[24:27], s30 offen sc1
s_add_u32 s30, s28, 24576
s_waitcnt lgkmcnt(3)
buffer_store_dwordx4 v[20:23], v1, s[24:27], s30 offen sc1
s_add_u32 s30, s28, 32768
s_waitcnt lgkmcnt(2)
buffer_store_dwordx4 v[24:27], v1, s[24:27], s30 offen sc1
s_add_u32 s30, s28, 40960
s_waitcnt lgkmcnt(1)
buffer_store_dwordx4 v[28:31], v1, s[24:27], s30 offen sc1
s_add_u32 s30, s28, 49152
s_waitcnt lgkmcnt(0)
buffer_store_dwordx4 v[32:35], v1, s[24:27], s30 offen sc1
s_cmp_ge_u32 s35, 320
s_cbranch_scc1 P_PR2
ds_read_b128 v[48:51], v1 offset:59408
s_add_u32 s30, s28, 57344
s_waitcnt lgkmcnt(0)
buffer_store_dwordx4 v[48:51], v1, s[24:27], s30 offen sc1
P_PR2:
s_cmp_lg_u32 s35, 448
s_cbranch_scc1 P_FIN
s_cmp_ge_u32 s2, 5
s_cbranch_scc1 P_FIN
v_lshl_or_b32 v136, v129, 16, v128
v_lshl_or_b32 v137, v131, 16, v130
v_lshl_or_b32 v138, v133, 16, v132
v_lshl_or_b32 v139, v135, 16, v134
s_lshl_b32 s30, s2, 10
s_add_u32 s30, s30, 16245760
buffer_store_dwordx4 v[136:139], v1, s[24:27], s30 offen
P_FIN:
P_EXIT:
s_endpgm
.globl gath_kernel
.p2align 8
.type gath_kernel,@function
gath_kernel:
s_cmp_ge_u32 s2, 256
s_cbranch_scc1 G_EXIT
s_lshr_b32 s63, s2, 3
s_and_b32 s4, s2, 7
s_lshl_b32 s4, s4, 5
s_add_u32 s2, s4, s63
s_mul_i32 s63, s63, 40064
s_load_dwordx2 s[4:5], s[0:1], 0
s_load_dwordx2 s[6:7], s[0:1], 24
s_load_dwordx2 s[8:9], s[0:1], 88
s_load_dwordx2 s[10:11], s[0:1], 104
s_load_dwordx2 s[36:37], s[0:1], 40
v_lshrrev_b32 v2, 6, v0
v_and_b32 v4, 63, v0
v_readfirstlane_b32 s3, v2
v_lshlrev_b32 v1, 4, v4
v_min_u32 v3, 6, v2
v_mad_u32_u24 v2, v2, 25, v3
v_add_u32 v2, v2, v4
v_lshlrev_b32 v5, 10, v2
v_mov_b32 v3, 0
v_mov_b32 v15, 1
s_lshl_b32 s30, s2, 2
s_add_u32 s30, s30, 15990784
s_waitcnt lgkmcnt(0)
s_mov_b32 s24, s10
s_mov_b32 s25, s11
s_mov_b32 s26, 16258048
s_mov_b32 s27, 0x00020000
s_cmp_lt_u32 s3, 6
s_mov_b32 s38, 0x1ffffff
s_cselect_b32 exec_lo, 0x3ffffff, s38
s_mov_b32 exec_hi, 0
buffer_load_dword v3, v5, s[24:27], s30 offen
s_mov_b64 exec, -1
s_mov_b32 s16, s4
s_mov_b32 s17, s5
s_mov_b32 s18, 5120000
s_mov_b32 s19, 0x00020000
s_mov_b32 s20, s6
s_mov_b32 s21, s7
s_mov_b32 s22, 320000
s_mov_b32 s23, 0x00020000
s_mov_b32 s32, s8
s_mov_b32 s33, s9
s_mov_b32 s34, 5120000
s_mov_b32 s35, 0x00020000
v_subrev_u32 v7, 256, v0
v_cmp_gt_u32 vcc, 313, v7
v_lshl_add_u32 v7, v7, 7, s63
v_bfrev_b32 v118, 1
v_cndmask_b32 v118, v118, v7, vcc
s_lshl_b32 s45, s3, 8
s_add_u32 s45, s45, 10272
v_lshl_add_u32 v13, v4, 2, s45
v_lshlrev_b32 v5, 4, v0
v_mov_b32 v8, 0
v_mov_b32 v9, 0
v_mov_b32 v10, 0
v_mov_b32 v11, 0
ds_write_b32 v13, v8
ds_write_b128 v5, v[8:11]
v_lshlrev_b32 v5, 2, v0
ds_write_b32 v5, v8 offset:12848
ds_write_b32 v5, v8 offset:15408
v_mov_b32 v5, 0xffffc000
v_mov_b32 v6, 18240
ds_write2_b32 v6, v5, v8 offset0:0 offset1:1
v_mov_b32 v6, 10256
ds_write_b32 v6, v8
s_waitcnt lgkmcnt(0)
s_barrier
s_load_dwordx4 s[40:43], s[36:37], 0
s_mov_b32 s31, 16252928
buffer_load_dwordx4 v[120:123], v1, s[24:27], s31 offen offset:0
buffer_load_dwordx4 v[124:127], v1, s[24:27], s31 offen offset:1024
buffer_load_dwordx4 v[128:131], v1, s[24:27], s31 offen offset:2048
buffer_load_dwordx4 v[132:135], v1, s[24:27], s31 offen offset:3072
s_add_u32 s31, s31, 4096
buffer_load_dwordx4 v[136:139], v1, s[24:27], s31 offen offset:0
v_mul_u32_u24 v2, 62464, v2
v_mov_b32 v16, 0
v_mov_b32 v17, 0
v_mov_b32 v18, 0
v_mov_b32 v19, 0
v_mov_b32 v20, 0
v_mov_b32 v21, 0
v_mov_b32 v22, 0
v_mov_b32 v23, 0
v_mov_b32 v24, 0
v_mov_b32 v25, 0
v_mov_b32 v26, 0
v_mov_b32 v27, 0
v_mov_b32 v28, 0
v_mov_b32 v29, 0
v_mov_b32 v30, 0
v_mov_b32 v31, 0
v_mov_b32 v32, 0
v_mov_b32 v33, 0
v_mov_b32 v34, 0
v_mov_b32 v35, 0
v_mov_b32 v36, 0
v_mov_b32 v37, 0
v_mov_b32 v38, 0
v_mov_b32 v39, 0
v_mov_b32 v40, 0
v_mov_b32 v41, 0
v_mov_b32 v42, 0
v_mov_b32 v43, 0
v_mov_b32 v44, 0
v_mov_b32 v45, 0
v_mov_b32 v46, 0
v_mov_b32 v47, 0
s_mov_b32 s44, 0
v_mov_b32 v119, 0
v_mov_b32 v148, 0
v_mov_b32 v149, 0
s_mul_i32 s39, s2, 20000
s_mov_b32 s52, 0xffff0000
s_movk_i32 s53, 0x3fff
s_mov_b32 s54, 0x1fff8
s_mul_i32 s55, s3, 10240
s_add_u32 s55, s55, 18256
v_and_b32 v14, 1, v4
v_lshlrev_b32 v14, 4, v14
s_waitcnt vmcnt(5)
v_and_b32 v5, 0xffff, v3
v_lshl_add_u32 v2, v5, 2, v2
v_lshrrev_b32 v3, 16, v3
G_ROUND:
v_mov_b32 v7, v3
s_nop 1
v_add_u32_dpp v7, v7, v7 row_shr:1 row_mask:0xf bank_mask:0xf bound_ctrl:0
s_nop 1
v_add_u32_dpp v7, v7, v7 row_shr:2 row_mask:0xf bank_mask:0xf bound_ctrl:0
s_nop 1
v_add_u32_dpp v7, v7, v7 row_shr:4 row_mask:0xf bank_mask:0xf bound_ctrl:0
s_nop 1
v_add_u32_dpp v7, v7, v7 row_shr:8 row_mask:0xf bank_mask:0xf bound_ctrl:0
s_nop 1
v_add_u32_dpp v7, v7, v7 row_bcast:15 row_mask:0xa bank_mask:0xf
v_sub_u32 v6, v7, v3
v_min_u32 v7, 640, v7
v_min_u32 v6, 640, v6
v_sub_u32 v8, v7, v6
v_readlane_b32 s49, v7, 31
v_cmp_lt_u32 vcc, 0, v8
v_mul_u32_u24 v9, 12, v6
v_sub_u32 v9, v2, v9
v_mbcnt_lo_u32_b32 v10, vcc_lo, 0
v_lshl_add_u32 v10, v10, 2, s45
v_subrev_u32 v6, 1, v6
v_lshlrev_b32 v11, v6, v15
v_ashrrev_i32 v6, 5, v6
v_lshl_add_u32 v6, v6, 2, s45
s_mov_b64 exec, vcc
ds_write_b32 v10, v9 offset:128
ds_or_b32 v6, v11 offset:4
s_mov_b64 exec, -1
ds_read_b32 v6, v13 offset:4
v_mad_u32_u24 v2, v8, 12, v2
v_sub_u32 v3, v3, v8
v_cmp_lt_u32 vcc, 0, v3
s_add_u32 s50, s49, 63
s_lshr_b32 s50, s50, 6
s_mov_b32 s46, vcc_lo
s_sub_u32 s51, 0, s49
s_and_b32 s51, s51, 63
s_lshr_b64 s[58:59], -1, s51
s_lshr_b32 s47, s45, 2
s_add_u32 s47, s47, 32
s_waitcnt lgkmcnt(0)
v_readlane_b32 s60, v6, 0
v_readlane_b32 s61, v6, 1
v_mov_b32 v7, s47
s_nop 0
v_mbcnt_lo_u32_b32 v7, s60, v7
v_mbcnt_hi_u32_b32 v7, s61, v7
s_bcnt1_i32_b64 s48, s[60:61]
v_lshlrev_b32 v7, 2, v7
s_add_u32 s47, s47, s48
ds_read_b32 v88, v7
v_readlane_b32 s60, v6, 2
v_readlane_b32 s61, v6, 3
v_mov_b32 v7, s47
s_nop 0
v_mbcnt_lo_u32_b32 v7, s60, v7
v_mbcnt_hi_u32_b32 v7, s61, v7
s_bcnt1_i32_b64 s48, s[60:61]
v_lshlrev_b32 v7, 2, v7
s_add_u32 s47, s47, s48
ds_read_b32 v89, v7
v_readlane_b32 s60, v6, 4
v_readlane_b32 s61, v6, 5
v_mov_b32 v7, s47
s_nop 0
v_mbcnt_lo_u32_b32 v7, s60, v7
v_mbcnt_hi_u32_b32 v7, s61, v7
s_bcnt1_i32_b64 s48, s[60:61]
v_lshlrev_b32 v7, 2, v7
s_add_u32 s47, s47, s48
ds_read_b32 v90, v7
v_readlane_b32 s60, v6, 6
v_readlane_b32 s61, v6, 7
v_mov_b32 v7, s47
s_nop 0
v_mbcnt_lo_u32_b32 v7, s60, v7
v_mbcnt_hi_u32_b32 v7, s61, v7
s_bcnt1_i32_b64 s48, s[60:61]
v_lshlrev_b32 v7, 2, v7
s_add_u32 s47, s47, s48
ds_read_b32 v91, v7
v_readlane_b32 s60, v6, 8
v_readlane_b32 s61, v6, 9
v_mov_b32 v7, s47
s_nop 0
v_mbcnt_lo_u32_b32 v7, s60, v7
v_mbcnt_hi_u32_b32 v7, s61, v7
s_bcnt1_i32_b64 s48, s[60:61]
v_lshlrev_b32 v7, 2, v7
s_add_u32 s47, s47, s48
ds_read_b32 v92, v7
v_readlane_b32 s60, v6, 10
v_readlane_b32 s61, v6, 11
v_mov_b32 v7, s47
s_nop 0
v_mbcnt_lo_u32_b32 v7, s60, v7
v_mbcnt_hi_u32_b32 v7, s61, v7
s_bcnt1_i32_b64 s48, s[60:61]
v_lshlrev_b32 v7, 2, v7
s_add_u32 s47, s47, s48
ds_read_b32 v93, v7
v_readlane_b32 s60, v6, 12
v_readlane_b32 s61, v6, 13
v_mov_b32 v7, s47
s_nop 0
v_mbcnt_lo_u32_b32 v7, s60, v7
v_mbcnt_hi_u32_b32 v7, s61, v7
s_bcnt1_i32_b64 s48, s[60:61]
v_lshlrev_b32 v7, 2, v7
s_add_u32 s47, s47, s48
ds_read_b32 v94, v7
v_readlane_b32 s60, v6, 14
v_readlane_b32 s61, v6, 15
v_mov_b32 v7, s47
s_nop 0
v_mbcnt_lo_u32_b32 v7, s60, v7
v_mbcnt_hi_u32_b32 v7, s61, v7
s_bcnt1_i32_b64 s48, s[60:61]
v_lshlrev_b32 v7, 2, v7
s_add_u32 s47, s47, s48
ds_read_b32 v95, v7
v_readlane_b32 s60, v6, 16
v_readlane_b32 s61, v6, 17
v_mov_b32 v7, s47
s_nop 0
v_mbcnt_lo_u32_b32 v7, s60, v7
v_mbcnt_hi_u32_b32 v7, s61, v7
s_bcnt1_i32_b64 s48, s[60:61]
v_lshlrev_b32 v7, 2, v7
s_add_u32 s47, s47, s48
ds_read_b32 v96, v7
v_readlane_b32 s60, v6, 18
v_readlane_b32 s61, v6, 19
v_mov_b32 v7, s47
s_nop 0
v_mbcnt_lo_u32_b32 v7, s60, v7
v_mbcnt_hi_u32_b32 v7, s61, v7
s_bcnt1_i32_b64 s48, s[60:61]
v_lshlrev_b32 v7, 2, v7
s_add_u32 s47, s47, s48
ds_read_b32 v97, v7
s_mov_b32 s48, 0
s_waitcnt lgkmcnt(9)
v_mad_u32_u24 v88, v4, 12, v88
s_cmp_gt_u32 s50, 0
s_cselect_b64 exec, -1, 1
buffer_load_dwordx3 v[48:50], v88, s[24:27], s48 offen offset:0
s_waitcnt lgkmcnt(8)
v_mad_u32_u24 v89, v4, 12, v89
s_cmp_gt_u32 s50, 1
s_cselect_b64 exec, -1, 1
buffer_load_dwordx3 v[52:54], v89, s[24:27], s48 offen offset:768
s_waitcnt lgkmcnt(7)
v_mad_u32_u24 v90, v4, 12, v90
s_cmp_gt_u32 s50, 2
s_cselect_b64 exec, -1, 1
buffer_load_dwordx3 v[56:58], v90, s[24:27], s48 offen offset:1536
s_waitcnt lgkmcnt(6)
v_mad_u32_u24 v91, v4, 12, v91
s_cmp_gt_u32 s50, 3
s_cselect_b64 exec, -1, 1
buffer_load_dwordx3 v[60:62], v91, s[24:27], s48 offen offset:2304
s_waitcnt lgkmcnt(5)
v_mad_u32_u24 v92, v4, 12, v92
s_cmp_gt_u32 s50, 4
s_cselect_b64 exec, -1, 1
buffer_load_dwordx3 v[64:66], v92, s[24:27], s48 offen offset:3072
s_waitcnt lgkmcnt(4)
v_mad_u32_u24 v93, v4, 12, v93
s_add_u32 s48, s48, 3840
s_cmp_gt_u32 s50, 5
s_cselect_b64 exec, -1, 1
buffer_load_dwordx3 v[68:70], v93, s[24:27], s48 offen offset:0
s_waitcnt lgkmcnt(3)
v_mad_u32_u24 v94, v4, 12, v94
s_cmp_gt_u32 s50, 6
s_cselect_b64 exec, -1, 1
buffer_load_dwordx3 v[72:74], v94, s[24:27], s48 offen offset:768
s_waitcnt lgkmcnt(2)
v_mad_u32_u24 v95, v4, 12, v95
s_cmp_gt_u32 s50, 7
s_cselect_b64 exec, -1, 1
buffer_load_dwordx3 v[76:78], v95, s[24:27], s48 offen offset:1536
s_waitcnt lgkmcnt(1)
v_mad_u32_u24 v96, v4, 12, v96
s_cmp_gt_u32 s50, 8
s_cselect_b64 exec, -1, 1
buffer_load_dwordx3 v[80:82], v96, s[24:27], s48 offen offset:2304
s_waitcnt lgkmcnt(0)
v_mad_u32_u24 v97, v4, 12, v97
s_cmp_gt_u32 s50, 9
s_cselect_b64 exec, -1, 1
buffer_load_dwordx3 v[84:86], v97, s[24:27], s48 offen offset:3072
s_mov_b64 exec, -1
G_F3:
s_cmp_eq_u32 s46, 0
s_cbranch_scc1 G_NOMORE
s_add_u32 s30, s44, 1
v_mov_b32 v5, s30
v_mov_b32 v6, 10256
ds_max_u32 v6, v5
G_NOMORE:
v_add_u32 v5, s55, v1
v_subrev_u32 v6, 18240, v5
v_lshrrev_b32 v6, 3, v6
s_mov_b32 s30, 0x3e22f983
s_mov_b32 s31, s30
s_mov_b32 s60, -1.0
s_mov_b32 s61, -1.0
s_cmp_le_u32 s50, 0
s_cbranch_scc1 G_LE0
s_cmp_eq_u32 s50, 1
s_cselect_b64 exec, s[58:59], -1
s_waitcnt vmcnt(9)
v_and_b32 v8, s53, v48
v_and_b32 v9, s53, v50
v_and_b32 v10, -4, v8
v_and_b32 v11, -4, v9
v_lshlrev_b32 v8, 2, v8
v_lshlrev_b32 v9, 2, v9
v_add_u32 v7, 1, v6
ds_wrxchg_rtn_b32 v98, v8, v6
ds_wrxchg_rtn_b32 v99, v9, v7
ds_add_u32 v10, v15 offset:12848
ds_add_u32 v11, v15 offset:12848
s_mov_b64 exec, -1
v_lshlrev_b32 v8, 16, v49
v_and_b32 v9, s52, v49
v_pk_mul_f32 v[8:9], v[8:9], s[30:31]
v_cos_f32 v8, v8
v_cos_f32 v9, v9
v_add_u32 v6, 128, v6
v_pk_add_f32 v[10:11], v[8:9], v[8:9]
v_pk_fma_f32 v[10:11], v[10:11], v[8:9], s[60:61]
v_cvt_pk_bf16_f32 v49, v8, v10
v_cvt_pk_bf16_f32 v51, v9, v11
s_cmp_le_u32 s50, 1
s_cbranch_scc1 G_LE1
s_cmp_eq_u32 s50, 2
s_cselect_b64 exec, s[58:59], -1
s_waitcnt vmcnt(8)
v_and_b32 v8, s53, v52
v_and_b32 v9, s53, v54
v_and_b32 v10, -4, v8
v_and_b32 v11, -4, v9
v_lshlrev_b32 v8, 2, v8
v_lshlrev_b32 v9, 2, v9
v_add_u32 v7, 1, v6
ds_wrxchg_rtn_b32 v100, v8, v6
ds_wrxchg_rtn_b32 v101, v9, v7
ds_add_u32 v10, v15 offset:12848
ds_add_u32 v11, v15 offset:12848
s_mov_b64 exec, -1
v_lshlrev_b32 v8, 16, v53
v_and_b32 v9, s52, v53
v_pk_mul_f32 v[8:9], v[8:9], s[30:31]
v_cos_f32 v8, v8
v_cos_f32 v9, v9
v_add_u32 v6, 128, v6
v_pk_add_f32 v[10:11], v[8:9], v[8:9]
v_pk_fma_f32 v[10:11], v[10:11], v[8:9], s[60:61]
v_cvt_pk_bf16_f32 v53, v8, v10
v_cvt_pk_bf16_f32 v55, v9, v11
s_waitcnt lgkmcnt(4)
v_bfi_b32 v48, s53, v98, v48
v_bfi_b32 v50, s53, v99, v50
ds_write_b128 v5, v[48:51] offset:0
s_cmp_le_u32 s50, 2
s_cbranch_scc1 G_LE2
s_cmp_eq_u32 s50, 3
s_cselect_b64 exec, s[58:59], -1
s_waitcnt vmcnt(7)
v_and_b32 v8, s53, v56
v_and_b32 v9, s53, v58
v_and_b32 v10, -4, v8
v_and_b32 v11, -4, v9
v_lshlrev_b32 v8, 2, v8
v_lshlrev_b32 v9, 2, v9
v_add_u32 v7, 1, v6
ds_wrxchg_rtn_b32 v102, v8, v6
ds_wrxchg_rtn_b32 v103, v9, v7
ds_add_u32 v10, v15 offset:12848
ds_add_u32 v11, v15 offset:12848
s_mov_b64 exec, -1
v_lshlrev_b32 v8, 16, v57
v_and_b32 v9, s52, v57
v_pk_mul_f32 v[8:9], v[8:9], s[30:31]
v_cos_f32 v8, v8
v_cos_f32 v9, v9
v_add_u32 v6, 128, v6
v_pk_add_f32 v[10:11], v[8:9], v[8:9]
v_pk_fma_f32 v[10:11], v[10:11], v[8:9], s[60:61]
v_cvt_pk_bf16_f32 v57, v8, v10
v_cvt_pk_bf16_f32 v59, v9, v11
s_waitcnt lgkmcnt(4)
v_bfi_b32 v52, s53, v100, v52
v_bfi_b32 v54, s53, v101, v54
ds_write_b128 v5, v[52:55] offset:1024
s_cmp_le_u32 s50, 3
s_cbranch_scc1 G_LE3
s_cmp_eq_u32 s50, 4
s_cselect_b64 exec, s[58:59], -1
s_waitcnt vmcnt(6)
v_and_b32 v8, s53, v60
v_and_b32 v9, s53, v62
v_and_b32 v10, -4, v8
v_and_b32 v11, -4, v9
v_lshlrev_b32 v8, 2, v8
v_lshlrev_b32 v9, 2, v9
v_add_u32 v7, 1, v6
ds_wrxchg_rtn_b32 v104, v8, v6
ds_wrxchg_rtn_b32 v105, v9, v7
ds_add_u32 v10, v15 offset:12848
ds_add_u32 v11, v15 offset:12848
s_mov_b64 exec, -1
v_lshlrev_b32 v8, 16, v61
v_and_b32 v9, s52, v61
v_pk_mul_f32 v[8:9], v[8:9], s[30:31]
v_cos_f32 v8, v8
v_cos_f32 v9, v9
v_add_u32 v6, 128, v6
v_pk_add_f32 v[10:11], v[8:9], v[8:9]
v_pk_fma_f32 v[10:11], v[10:11], v[8:9], s[60:61]
v_cvt_pk_bf16_f32 v61, v8, v10
v_cvt_pk_bf16_f32 v63, v9, v11
s_waitcnt lgkmcnt(4)
v_bfi_b32 v56, s53, v102, v56
v_bfi_b32 v58, s53, v103, v58
ds_write_b128 v5, v[56:59] offset:2048
s_cmp_le_u32 s50, 4
s_cbranch_scc1 G_LE4
s_cmp_eq_u32 s50, 5
s_cselect_b64 exec, s[58:59], -1
s_waitcnt vmcnt(5)
v_and_b32 v8, s53, v64
v_and_b32 v9, s53, v66
v_and_b32 v10, -4, v8
v_and_b32 v11, -4, v9
v_lshlrev_b32 v8, 2, v8
v_lshlrev_b32 v9, 2, v9
v_add_u32 v7, 1, v6
ds_wrxchg_rtn_b32 v106, v8, v6
ds_wrxchg_rtn_b32 v107, v9, v7
ds_add_u32 v10, v15 offset:12848
ds_add_u32 v11, v15 offset:12848
s_mov_b64 exec, -1
v_lshlrev_b32 v8, 16, v65
v_and_b32 v9, s52, v65
v_pk_mul_f32 v[8:9], v[8:9], s[30:31]
v_cos_f32 v8, v8
v_cos_f32 v9, v9
v_add_u32 v6, 128, v6
v_pk_add_f32 v[10:11], v[8:9], v[8:9]
v_pk_fma_f32 v[10:11], v[10:11], v[8:9], s[60:61]
v_cvt_pk_bf16_f32 v65, v8, v10
v_cvt_pk_bf16_f32 v67, v9, v11
s_waitcnt lgkmcnt(4)
v_bfi_b32 v60, s53, v104, v60
v_bfi_b32 v62, s53, v105, v62
ds_write_b128 v5, v[60:63] offset:3072
s_cmp_le_u32 s50, 5
s_cbranch_scc1 G_LE5
s_cmp_eq_u32 s50, 6
s_cselect_b64 exec, s[58:59], -1
s_waitcnt vmcnt(4)
v_and_b32 v8, s53, v68
v_and_b32 v9, s53, v70
v_and_b32 v10, -4, v8
v_and_b32 v11, -4, v9
v_lshlrev_b32 v8, 2, v8
v_lshlrev_b32 v9, 2, v9
v_add_u32 v7, 1, v6
ds_wrxchg_rtn_b32 v108, v8, v6
ds_wrxchg_rtn_b32 v109, v9, v7
ds_add_u32 v10, v15 offset:12848
ds_add_u32 v11, v15 offset:12848
s_mov_b64 exec, -1
v_lshlrev_b32 v8, 16, v69
v_and_b32 v9, s52, v69
v_pk_mul_f32 v[8:9], v[8:9], s[30:31]
v_cos_f32 v8, v8
v_cos_f32 v9, v9
v_add_u32 v6, 128, v6
v_pk_add_f32 v[10:11], v[8:9], v[8:9]
v_pk_fma_f32 v[10:11], v[10:11], v[8:9], s[60:61]
v_cvt_pk_bf16_f32 v69, v8, v10
v_cvt_pk_bf16_f32 v71, v9, v11
s_waitcnt lgkmcnt(4)
v_bfi_b32 v64, s53, v106, v64
v_bfi_b32 v66, s53, v107, v66
ds_write_b128 v5, v[64:67] offset:4096
s_cmp_le_u32 s50, 6
s_cbranch_scc1 G_LE6
s_cmp_eq_u32 s50, 7
s_cselect_b64 exec, s[58:59], -1
s_waitcnt vmcnt(3)
v_and_b32 v8, s53, v72
v_and_b32 v9, s53, v74
v_and_b32 v10, -4, v8
v_and_b32 v11, -4, v9
v_lshlrev_b32 v8, 2, v8
v_lshlrev_b32 v9, 2, v9
v_add_u32 v7, 1, v6
ds_wrxchg_rtn_b32 v110, v8, v6
ds_wrxchg_rtn_b32 v111, v9, v7
ds_add_u32 v10, v15 offset:12848
ds_add_u32 v11, v15 offset:12848
s_mov_b64 exec, -1
v_lshlrev_b32 v8, 16, v73
v_and_b32 v9, s52, v73
v_pk_mul_f32 v[8:9], v[8:9], s[30:31]
v_cos_f32 v8, v8
v_cos_f32 v9, v9
v_add_u32 v6, 128, v6
v_pk_add_f32 v[10:11], v[8:9], v[8:9]
v_pk_fma_f32 v[10:11], v[10:11], v[8:9], s[60:61]
v_cvt_pk_bf16_f32 v73, v8, v10
v_cvt_pk_bf16_f32 v75, v9, v11
s_waitcnt lgkmcnt(4)
v_bfi_b32 v68, s53, v108, v68
v_bfi_b32 v70, s53, v109, v70
ds_write_b128 v5, v[68:71] offset:5120
s_cmp_le_u32 s50, 7
s_cbranch_scc1 G_LE7
s_cmp_eq_u32 s50, 8
s_cselect_b64 exec, s[58:59], -1
s_waitcnt vmcnt(2)
v_and_b32 v8, s53, v76
v_and_b32 v9, s53, v78
v_and_b32 v10, -4, v8
v_and_b32 v11, -4, v9
v_lshlrev_b32 v8, 2, v8
v_lshlrev_b32 v9, 2, v9
v_add_u32 v7, 1, v6
ds_wrxchg_rtn_b32 v112, v8, v6
ds_wrxchg_rtn_b32 v113, v9, v7
ds_add_u32 v10, v15 offset:12848
ds_add_u32 v11, v15 offset:12848
s_mov_b64 exec, -1
v_lshlrev_b32 v8, 16, v77
v_and_b32 v9, s52, v77
v_pk_mul_f32 v[8:9], v[8:9], s[30:31]
v_cos_f32 v8, v8
v_cos_f32 v9, v9
v_add_u32 v6, 128, v6
v_pk_add_f32 v[10:11], v[8:9], v[8:9]
v_pk_fma_f32 v[10:11], v[10:11], v[8:9], s[60:61]
v_cvt_pk_bf16_f32 v77, v8, v10
v_cvt_pk_bf16_f32 v79, v9, v11
s_waitcnt lgkmcnt(4)
v_bfi_b32 v72, s53, v110, v72
v_bfi_b32 v74, s53, v111, v74
ds_write_b128 v5, v[72:75] offset:6144
s_cmp_le_u32 s50, 8
s_cbranch_scc1 G_LE8
s_cmp_eq_u32 s50, 9
s_cselect_b64 exec, s[58:59], -1
s_waitcnt vmcnt(1)
v_and_b32 v8, s53, v80
v_and_b32 v9, s53, v82
v_and_b32 v10, -4, v8
v_and_b32 v11, -4, v9
v_lshlrev_b32 v8, 2, v8
v_lshlrev_b32 v9, 2, v9
v_add_u32 v7, 1, v6
ds_wrxchg_rtn_b32 v114, v8, v6
ds_wrxchg_rtn_b32 v115, v9, v7
ds_add_u32 v10, v15 offset:12848
ds_add_u32 v11, v15 offset:12848
s_mov_b64 exec, -1
v_lshlrev_b32 v8, 16, v81
v_and_b32 v9, s52, v81
v_pk_mul_f32 v[8:9], v[8:9], s[30:31]
v_cos_f32 v8, v8
v_cos_f32 v9, v9
v_add_u32 v6, 128, v6
v_pk_add_f32 v[10:11], v[8:9], v[8:9]
v_pk_fma_f32 v[10:11], v[10:11], v[8:9], s[60:61]
v_cvt_pk_bf16_f32 v81, v8, v10
v_cvt_pk_bf16_f32 v83, v9, v11
s_waitcnt lgkmcnt(4)
v_bfi_b32 v76, s53, v112, v76
v_bfi_b32 v78, s53, v113, v78
ds_write_b128 v5, v[76:79] offset:7168
s_cmp_le_u32 s50, 9
s_cbranch_scc1 G_LE9
s_cmp_eq_u32 s50, 10
s_cselect_b64 exec, s[58:59], -1
s_waitcnt vmcnt(0)
v_and_b32 v8, s53, v84
v_and_b32 v9, s53, v86
v_and_b32 v10, -4, v8
v_and_b32 v11, -4, v9
v_lshlrev_b32 v8, 2, v8
v_lshlrev_b32 v9, 2, v9
v_add_u32 v7, 1, v6
ds_wrxchg_rtn_b32 v116, v8, v6
ds_wrxchg_rtn_b32 v117, v9, v7
ds_add_u32 v10, v15 offset:12848
ds_add_u32 v11, v15 offset:12848
s_mov_b64 exec, -1
v_lshlrev_b32 v8, 16, v85
v_and_b32 v9, s52, v85
v_pk_mul_f32 v[8:9], v[8:9], s[30:31]
v_cos_f32 v8, v8
v_cos_f32 v9, v9
v_add_u32 v6, 128, v6
v_pk_add_f32 v[10:11], v[8:9], v[8:9]
v_pk_fma_f32 v[10:11], v[10:11], v[8:9], s[60:61]
v_cvt_pk_bf16_f32 v85, v8, v10
v_cvt_pk_bf16_f32 v87, v9, v11
s_waitcnt lgkmcnt(4)
v_bfi_b32 v80, s53, v114, v80
v_bfi_b32 v82, s53, v115, v82
ds_write_b128 v5, v[80:83] offset:8192
G_LE10:
s_waitcnt lgkmcnt(0)
v_bfi_b32 v84, s53, v116, v84
v_bfi_b32 v86, s53, v117, v86
ds_write_b128 v5, v[84:87] offset:9216
s_branch G_LE0
G_LE9:
s_waitcnt lgkmcnt(0)
v_bfi_b32 v80, s53, v114, v80
v_bfi_b32 v82, s53, v115, v82
ds_write_b128 v5, v[80:83] offset:8192
s_branch G_LE0
G_LE8:
s_waitcnt lgkmcnt(0)
v_bfi_b32 v76, s53, v112, v76
v_bfi_b32 v78, s53, v113, v78
ds_write_b128 v5, v[76:79] offset:7168
s_branch G_LE0
G_LE7:
s_waitcnt lgkmcnt(0)
v_bfi_b32 v72, s53, v110, v72
v_bfi_b32 v74, s53, v111, v74
ds_write_b128 v5, v[72:75] offset:6144
s_branch G_LE0
G_LE6:
s_waitcnt lgkmcnt(0)
v_bfi_b32 v68, s53, v108, v68
v_bfi_b32 v70, s53, v109, v70
ds_write_b128 v5, v[68:71] offset:5120
s_branch G_LE0
G_LE5:
s_waitcnt lgkmcnt(0)
v_bfi_b32 v64, s53, v106, v64
v_bfi_b32 v66, s53, v107, v66
ds_write_b128 v5, v[64:67] offset:4096
s_branch G_LE0
G_LE4:
s_waitcnt lgkmcnt(0)
v_bfi_b32 v60, s53, v104, v60
v_bfi_b32 v62, s53, v105, v62
ds_write_b128 v5, v[60:63] offset:3072
s_branch G_LE0
G_LE3:
s_waitcnt lgkmcnt(0)
v_bfi_b32 v56, s53, v102, v56
v_bfi_b32 v58, s53, v103, v58
ds_write_b128 v5, v[56:59] offset:2048
s_branch G_LE0
G_LE2:
s_waitcnt lgkmcnt(0)
v_bfi_b32 v52, s53, v100, v52
v_bfi_b32 v54, s53, v101, v54
ds_write_b128 v5, v[52:55] offset:1024
s_branch G_LE0
G_LE1:
s_waitcnt lgkmcnt(0)
v_bfi_b32 v48, s53, v98, v48
v_bfi_b32 v50, s53, v99, v50
ds_write_b128 v5, v[48:51] offset:0
G_LE0:
buffer_load_dword v12, v118, s[16:19], 0 offen
v_add_u32 v118, 1282048, v118
s_setprio 3
v_lshlrev_b32 v5, 2, v0
s_waitcnt lgkmcnt(0)
s_barrier
s_waitcnt vmcnt(1)
s_cmp_lg_u32 s44, 0
s_cbranch_scc1 G_SORTED
ds_read_b32 v6, v5 offset:12848
s_waitcnt lgkmcnt(0)
v_min_u32 v6, 63, v6
v_lshlrev_b32 v6, 2, v6
ds_add_rtn_u32 v7, v6, v15 offset:15424
v_lshlrev_b32 v8, 2, v4
s_waitcnt lgkmcnt(0)
s_barrier
ds_read_b32 v9, v8 offset:15424
s_waitcnt lgkmcnt(0)
v_mov_b32 v10, v9
s_nop 1
v_add_u32_dpp v10, v10, v10 row_shr:1 row_mask:0xf bank_mask:0xf bound_ctrl:0
s_nop 1
v_add_u32_dpp v10, v10, v10 row_shr:2 row_mask:0xf bank_mask:0xf bound_ctrl:0
s_nop 1
v_add_u32_dpp v10, v10, v10 row_shr:4 row_mask:0xf bank_mask:0xf bound_ctrl:0
s_nop 1
v_add_u32_dpp v10, v10, v10 row_shr:8 row_mask:0xf bank_mask:0xf bound_ctrl:0
s_nop 1
v_add_u32_dpp v10, v10, v10 row_bcast:15 row_mask:0xa bank_mask:0xf
s_nop 1
v_add_u32_dpp v10, v10, v10 row_bcast:31 row_mask:0xc bank_mask:0xf
v_sub_u32 v10, v10, v9
ds_bpermute_b32 v10, v6, v10
s_mov_b32 s60, 0x75238946
s_movk_i32 s61, 0x10
s_lshl_b32 s48, s3, 2
s_lshr_b64 s[60:61], s[60:61], s48
s_and_b32 s60, s60, 15
s_lshl_b32 s60, s60, 8
s_waitcnt lgkmcnt(0)
v_add_lshl_u32 v10, v10, v7, 2
ds_write_b32 v10, v5 offset:15680
v_add_u32 v8, s60, v8
s_waitcnt lgkmcnt(0)
s_barrier
ds_read_b32 v119, v8 offset:15680
s_waitcnt lgkmcnt(0)
v_cmp_gt_u32 vcc, 2500, v119
v_lshlrev_b32 v148, 3, v119
v_bfrev_b32 v8, 1
v_cndmask_b32 v148, v8, v148, vcc
v_add_u32 v149, 16, v148
v_lshrrev_b32 v8, 4, v148
s_mul_i32 s31, s2, 1250
buffer_load_ushort v153, v8, s[20:23], s31 offen
v_permlane32_swap_b32 v148, v149
buffer_load_dwordx4 v[140:143], v148, s[16:19], s39 offen
buffer_load_dwordx4 v[144:147], v149, s[16:19], s39 offen
G_SORTED:
v_lshlrev_b32 v5, 2, v119
v_mov_b32 v6, 10256
ds_read_b128 v[92:95], v5
ds_read_b32 v6, v6
ds_read_b32 v7, v119 offset:12848
s_waitcnt lgkmcnt(0)
v_readlane_b32 s47, v7, 63
s_mov_b32 s57, 3
s_mov_b32 s48, 0
s_mul_i32 s49, s47, 4
s_mul_i32 s50, s47, 8
s_mul_i32 s51, s47, 12
v_readfirstlane_b32 s56, v6
v_lshlrev_b32 v92, 3, v92
v_lshlrev_b32 v93, 3, v93
v_lshlrev_b32 v94, 3, v94
v_lshlrev_b32 v95, 3, v95
v_cmp_eq_u32 vcc, 0, v94
s_nop 1
v_cndmask_b32 v94, v94, v95, vcc
v_cndmask_b32 v95, v95, 0, vcc
v_cmp_eq_u32 vcc, 0, v93
s_nop 1
v_cndmask_b32 v93, v93, v94, vcc
v_cndmask_b32 v94, v94, v95, vcc
v_cndmask_b32 v95, v95, 0, vcc
v_cmp_eq_u32 vcc, 0, v92
s_nop 1
v_cndmask_b32 v92, v92, v93, vcc
v_cndmask_b32 v93, v93, v94, vcc
v_cndmask_b32 v94, v94, v95, vcc
v_cndmask_b32 v95, v95, 0, vcc
ds_read_b64 v[84:85], v92 offset:18240
s_movk_i32 s62, 0x2000
s_mov_b32 s30, 0x05040100
s_mov_b32 s31, 0x07060302
s_waitcnt lgkmcnt(0)
v_lshrrev_b32 v5, 9, v84
v_and_b32 v5, -32, v5
v_lshlrev_b32 v92, 3, v84
v_and_b32 v92, s54, v92
v_add_u32_dpp v6, v5, v14 quad_perm:[0,0,2,2] row_mask:0xf bank_mask:0xf
v_add_u32_dpp v7, v5, v14 quad_perm:[1,1,3,3] row_mask:0xf bank_mask:0xf
v_cmp_eq_u32 vcc, 0, v92
buffer_load_dwordx4 v[48:51], v6, s[16:19], 0 offen
buffer_load_dwordx4 v[52:55], v7, s[16:19], 0 offen
v_cndmask_b32 v92, v92, v93, vcc
v_cndmask_b32 v93, v93, v94, vcc
v_cndmask_b32 v94, v94, v95, vcc
v_cndmask_b32 v95, v95, 0, vcc
ds_read_b64 v[86:87], v92 offset:18240
s_waitcnt lgkmcnt(0)
v_lshrrev_b32 v5, 9, v86
v_and_b32 v5, -32, v5
v_lshlrev_b32 v92, 3, v86
v_and_b32 v92, s54, v92
v_add_u32_dpp v6, v5, v14 quad_perm:[0,0,2,2] row_mask:0xf bank_mask:0xf
v_add_u32_dpp v7, v5, v14 quad_perm:[1,1,3,3] row_mask:0xf bank_mask:0xf
v_cmp_eq_u32 vcc, 0, v92
buffer_load_dwordx4 v[56:59], v6, s[16:19], 0 offen
buffer_load_dwordx4 v[60:63], v7, s[16:19], 0 offen
v_cndmask_b32 v92, v92, v93, vcc
v_cndmask_b32 v93, v93, v94, vcc
v_cndmask_b32 v94, v94, v95, vcc
v_cndmask_b32 v95, v95, 0, vcc
ds_read_b64 v[88:89], v92 offset:18240
s_cmp_lg_u32 s44, 0
s_cbranch_scc1 G_NORBF
s_mov_b32 s58, 0xc1200000
s_mov_b32 s59, 0x3fb8aa3b
s_waitcnt vmcnt(6)
v_lshlrev_b32 v10, 16, v153
s_lshl_b32 s60, s40, 16
s_and_b32 s61, s40, 0xffff0000
v_subrev_f32 v8, s60, v10
v_subrev_f32 v9, s61, v10
v_cvt_pk_bf16_f32 v9, v8, v9
v_lshlrev_b32 v8, 16, v9
v_and_b32 v9, s52, v9
v_mul_f32 v8, v8, v8
v_mul_f32 v9, v9, v9
v_cvt_pk_bf16_f32 v9, v8, v9
v_lshlrev_b32 v8, 16, v9
v_and_b32 v9, s52, v9
v_mul_f32 v8, s58, v8
v_mul_f32 v9, s58, v9
v_cvt_pk_bf16_f32 v9, v8, v9
v_lshlrev_b32 v8, 16, v9
v_and_b32 v9, s52, v9
v_mul_f32 v8, s59, v8
v_mul_f32 v9, s59, v9
v_exp_f32 v8, v8
v_exp_f32 v9, v9
v_mov_b32 v154, 0
v_cvt_pk_bf16_f32 v150, v8, v9
s_lshl_b32 s60, s41, 16
s_and_b32 s61, s41, 0xffff0000
v_subrev_f32 v8, s60, v10
v_subrev_f32 v9, s61, v10
v_cvt_pk_bf16_f32 v9, v8, v9
v_lshlrev_b32 v8, 16, v9
v_and_b32 v9, s52, v9
v_mul_f32 v8, v8, v8
v_mul_f32 v9, v9, v9
v_cvt_pk_bf16_f32 v9, v8, v9
v_lshlrev_b32 v8, 16, v9
v_and_b32 v9, s52, v9
v_mul_f32 v8, s58, v8
v_mul_f32 v9, s58, v9
v_cvt_pk_bf16_f32 v9, v8, v9
v_lshlrev_b32 v8, 16, v9
v_and_b32 v9, s52, v9
v_mul_f32 v8, s59, v8
v_mul_f32 v9, s59, v9
v_exp_f32 v8, v8
v_exp_f32 v9, v9
v_mov_b32 v155, 0
v_cvt_pk_bf16_f32 v151, v8, v9
s_lshl_b32 s60, s42, 16
s_and_b32 s61, s42, 0xffff0000
v_subrev_f32 v8, s60, v10
v_subrev_f32 v9, s61, v10
v_cvt_pk_bf16_f32 v9, v8, v9
v_lshlrev_b32 v8, 16, v9
v_and_b32 v9, s52, v9
v_mul_f32 v8, v8, v8
v_mul_f32 v9, v9, v9
v_cvt_pk_bf16_f32 v9, v8, v9
v_lshlrev_b32 v8, 16, v9
v_and_b32 v9, s52, v9
v_mul_f32 v8, s58, v8
v_mul_f32 v9, s58, v9
v_cvt_pk_bf16_f32 v9, v8, v9
v_lshlrev_b32 v8, 16, v9
v_and_b32 v9, s52, v9
v_mul_f32 v8, s59, v8
v_mul_f32 v9, s59, v9
v_exp_f32 v8, v8
v_exp_f32 v9, v9
v_mov_b32 v156, 0
v_cvt_pk_bf16_f32 v152, v8, v9
s_lshl_b32 s60, s43, 16
s_and_b32 s61, s43, 0xffff0000
v_subrev_f32 v8, s60, v10
v_subrev_f32 v9, s61, v10
v_cvt_pk_bf16_f32 v9, v8, v9
v_lshlrev_b32 v8, 16, v9
v_and_b32 v9, s52, v9
v_mul_f32 v8, v8, v8
v_mul_f32 v9, v9, v9
v_cvt_pk_bf16_f32 v9, v8, v9
v_lshlrev_b32 v8, 16, v9
v_and_b32 v9, s52, v9
v_mul_f32 v8, s58, v8
v_mul_f32 v9, s58, v9
v_cvt_pk_bf16_f32 v9, v8, v9
v_lshlrev_b32 v8, 16, v9
v_and_b32 v9, s52, v9
v_mul_f32 v8, s59, v8
v_mul_f32 v9, s59, v9
v_exp_f32 v8, v8
v_exp_f32 v9, v9
v_mov_b32 v157, 0
v_cvt_pk_bf16_f32 v153, v8, v9
s_nop 1
v_permlane32_swap_b32 v150, v154
v_permlane32_swap_b32 v151, v155
v_permlane32_swap_b32 v152, v156
v_permlane32_swap_b32 v153, v157
G_NORBF:
v_cmp_ne_u32 vcc, 0, v92
v_perm_b32 v80, v87, v85, s30
v_perm_b32 v81, v87, v85, s31
s_add_u32 s48, s48, 32
s_cbranch_vccz G_DRP0
s_cmp_lt_u32 s48, s49
s_cbranch_scc1 G_NBP0
s_mov_b32 s49, s50
s_mov_b32 s50, s51
s_mov_b32 s51, -1
s_setprio 2
s_cmp_lg_u32 s50, -1
s_cbranch_scc1 G_NBP0
s_setprio 1
s_cmp_lg_u32 s49, -1
s_cbranch_scc1 G_NBP0
s_setprio 0
G_NBP0:
s_waitcnt lgkmcnt(0)
v_lshrrev_b32 v5, 9, v88
v_and_b32 v5, -32, v5
v_lshlrev_b32 v92, 3, v88
v_and_b32 v92, s54, v92
v_add_u32_dpp v6, v5, v14 quad_perm:[0,0,2,2] row_mask:0xf bank_mask:0xf
v_add_u32_dpp v7, v5, v14 quad_perm:[1,1,3,3] row_mask:0xf bank_mask:0xf
v_cmp_eq_u32 vcc, 0, v92
buffer_load_dwordx4 v[64:67], v6, s[16:19], 0 offen
buffer_load_dwordx4 v[68:71], v7, s[16:19], 0 offen
v_cndmask_b32 v92, v92, v93, vcc
v_cndmask_b32 v93, v93, v94, vcc
v_cndmask_b32 v94, v94, v95, vcc
v_cndmask_b32 v95, v95, 0, vcc
ds_read_b64 v[90:91], v92 offset:18240
s_waitcnt lgkmcnt(0)
v_lshrrev_b32 v5, 9, v90
v_and_b32 v5, -32, v5
v_lshlrev_b32 v92, 3, v90
v_and_b32 v92, s54, v92
v_add_u32_dpp v6, v5, v14 quad_perm:[0,0,2,2] row_mask:0xf bank_mask:0xf
v_add_u32_dpp v7, v5, v14 quad_perm:[1,1,3,3] row_mask:0xf bank_mask:0xf
v_cmp_eq_u32 vcc, 0, v92
buffer_load_dwordx4 v[72:75], v6, s[16:19], 0 offen
buffer_load_dwordx4 v[76:79], v7, s[16:19], 0 offen
v_cndmask_b32 v92, v92, v93, vcc
v_cndmask_b32 v93, v93, v94, vcc
v_cndmask_b32 v94, v94, v95, vcc
v_cndmask_b32 v95, v95, 0, vcc
ds_read_b64 v[84:85], v92 offset:18240
v_cmp_ne_u32 vcc, 0, v92
v_perm_b32 v82, v91, v89, s30
v_perm_b32 v83, v91, v89, s31
s_add_u32 s48, s48, 32
s_cbranch_vccz G_DRP2
s_cmp_lt_u32 s48, s49
s_cbranch_scc1 G_NBP2
s_mov_b32 s49, s50
s_mov_b32 s50, s51
s_mov_b32 s51, -1
s_setprio 2
s_cmp_lg_u32 s50, -1
s_cbranch_scc1 G_NBP2
s_setprio 1
s_cmp_lg_u32 s49, -1
s_cbranch_scc1 G_NBP2
s_setprio 0
G_NBP2:
G_LOOP:
s_waitcnt vmcnt(4)
v_perm_b32 v96, v56, v48, s30
v_perm_b32 v97, v56, v48, s31
v_perm_b32 v98, v57, v49, s30
v_perm_b32 v99, v57, v49, s31
v_perm_b32 v100, v58, v50, s30
v_perm_b32 v101, v58, v50, s31
v_perm_b32 v102, v59, v51, s30
v_perm_b32 v103, v59, v51, s31
v_perm_b32 v104, v60, v52, s30
v_perm_b32 v105, v60, v52, s31
v_perm_b32 v106, v61, v53, s30
v_perm_b32 v107, v61, v53, s31
v_perm_b32 v108, v62, v54, s30
v_perm_b32 v109, v62, v54, s31
v_perm_b32 v110, v63, v55, s30
v_perm_b32 v111, v63, v55, s31
s_waitcnt lgkmcnt(0)
v_lshrrev_b32 v5, 9, v84
v_and_b32 v5, -32, v5
v_lshlrev_b32 v92, 3, v84
v_and_b32 v92, s54, v92
v_add_u32_dpp v6, v5, v14 quad_perm:[0,0,2,2] row_mask:0xf bank_mask:0xf
v_add_u32_dpp v7, v5, v14 quad_perm:[1,1,3,3] row_mask:0xf bank_mask:0xf
v_cmp_eq_u32 vcc, 0, v92
buffer_load_dwordx4 v[48:51], v6, s[16:19], 0 offen
buffer_load_dwordx4 v[52:55], v7, s[16:19], 0 offen
v_cndmask_b32 v92, v92, v93, vcc
v_cndmask_b32 v93, v93, v94, vcc
v_cndmask_b32 v94, v94, v95, vcc
v_cndmask_b32 v95, v95, 0, vcc
ds_read_b64 v[86:87], v92 offset:18240
v_dot2c_f32_bf16_dpp v16, v80, v96 quad_perm:[0,0,2,2] row_mask:0xf bank_mask:0xf
v_dot2c_f32_bf16_dpp v17, v80, v97 quad_perm:[0,0,2,2] row_mask:0xf bank_mask:0xf
v_dot2c_f32_bf16_dpp v18, v80, v98 quad_perm:[0,0,2,2] row_mask:0xf bank_mask:0xf
v_dot2c_f32_bf16_dpp v19, v80, v99 quad_perm:[0,0,2,2] row_mask:0xf bank_mask:0xf
v_dot2c_f32_bf16_dpp v20, v80, v100 quad_perm:[0,0,2,2] row_mask:0xf bank_mask:0xf
v_dot2c_f32_bf16_dpp v21, v80, v101 quad_perm:[0,0,2,2] row_mask:0xf bank_mask:0xf
v_dot2c_f32_bf16_dpp v22, v80, v102 quad_perm:[0,0,2,2] row_mask:0xf bank_mask:0xf
v_dot2c_f32_bf16_dpp v23, v80, v103 quad_perm:[0,0,2,2] row_mask:0xf bank_mask:0xf
v_dot2c_f32_bf16_dpp v32, v81, v96 quad_perm:[0,0,2,2] row_mask:0xf bank_mask:0xf
v_dot2c_f32_bf16_dpp v33, v81, v97 quad_perm:[0,0,2,2] row_mask:0xf bank_mask:0xf
v_dot2c_f32_bf16_dpp v34, v81, v98 quad_perm:[0,0,2,2] row_mask:0xf bank_mask:0xf
v_dot2c_f32_bf16_dpp v35, v81, v99 quad_perm:[0,0,2,2] row_mask:0xf bank_mask:0xf
v_dot2c_f32_bf16_dpp v36, v81, v100 quad_perm:[0,0,2,2] row_mask:0xf bank_mask:0xf
v_dot2c_f32_bf16_dpp v37, v81, v101 quad_perm:[0,0,2,2] row_mask:0xf bank_mask:0xf
v_dot2c_f32_bf16_dpp v38, v81, v102 quad_perm:[0,0,2,2] row_mask:0xf bank_mask:0xf
v_dot2c_f32_bf16_dpp v39, v81, v103 quad_perm:[0,0,2,2] row_mask:0xf bank_mask:0xf
s_waitcnt lgkmcnt(0)
v_lshrrev_b32 v5, 9, v86
v_and_b32 v5, -32, v5
v_lshlrev_b32 v92, 3, v86
v_and_b32 v92, s54, v92
v_add_u32_dpp v6, v5, v14 quad_perm:[0,0,2,2] row_mask:0xf bank_mask:0xf
v_add_u32_dpp v7, v5, v14 quad_perm:[1,1,3,3] row_mask:0xf bank_mask:0xf
v_cmp_eq_u32 vcc, 0, v92
buffer_load_dwordx4 v[56:59], v6, s[16:19], 0 offen
buffer_load_dwordx4 v[60:63], v7, s[16:19], 0 offen
v_cndmask_b32 v92, v92, v93, vcc
v_cndmask_b32 v93, v93, v94, vcc
v_cndmask_b32 v94, v94, v95, vcc
v_cndmask_b32 v95, v95, 0, vcc
ds_read_b64 v[88:89], v92 offset:18240
v_dot2c_f32_bf16_dpp v24, v80, v104 quad_perm:[1,1,3,3] row_mask:0xf bank_mask:0xf
v_dot2c_f32_bf16_dpp v25, v80, v105 quad_perm:[1,1,3,3] row_mask:0xf bank_mask:0xf
v_dot2c_f32_bf16_dpp v26, v80, v106 quad_perm:[1,1,3,3] row_mask:0xf bank_mask:0xf
v_dot2c_f32_bf16_dpp v27, v80, v107 quad_perm:[1,1,3,3] row_mask:0xf bank_mask:0xf
v_dot2c_f32_bf16_dpp v28, v80, v108 quad_perm:[1,1,3,3] row_mask:0xf bank_mask:0xf
v_dot2c_f32_bf16_dpp v29, v80, v109 quad_perm:[1,1,3,3] row_mask:0xf bank_mask:0xf
v_dot2c_f32_bf16_dpp v30, v80, v110 quad_perm:[1,1,3,3] row_mask:0xf bank_mask:0xf
v_dot2c_f32_bf16_dpp v31, v80, v111 quad_perm:[1,1,3,3] row_mask:0xf bank_mask:0xf
v_dot2c_f32_bf16_dpp v40, v81, v104 quad_perm:[1,1,3,3] row_mask:0xf bank_mask:0xf
v_dot2c_f32_bf16_dpp v41, v81, v105 quad_perm:[1,1,3,3] row_mask:0xf bank_mask:0xf
v_dot2c_f32_bf16_dpp v42, v81, v106 quad_perm:[1,1,3,3] row_mask:0xf bank_mask:0xf
v_dot2c_f32_bf16_dpp v43, v81, v107 quad_perm:[1,1,3,3] row_mask:0xf bank_mask:0xf
v_dot2c_f32_bf16_dpp v44, v81, v108 quad_perm:[1,1,3,3] row_mask:0xf bank_mask:0xf
v_dot2c_f32_bf16_dpp v45, v81, v109 quad_perm:[1,1,3,3] row_mask:0xf bank_mask:0xf
v_dot2c_f32_bf16_dpp v46, v81, v110 quad_perm:[1,1,3,3] row_mask:0xf bank_mask:0xf
v_dot2c_f32_bf16_dpp v47, v81, v111 quad_perm:[1,1,3,3] row_mask:0xf bank_mask:0xf
v_cmp_ne_u32 vcc, 0, v92
v_perm_b32 v80, v87, v85, s30
v_perm_b32 v81, v87, v85, s31
s_add_u32 s48, s48, 32
s_cbranch_vccz G_DRL0
s_cmp_lt_u32 s48, s49
s_cbranch_scc1 G_NBL0
s_mov_b32 s49, s50
s_mov_b32 s50, s51
s_mov_b32 s51, -1
s_setprio 2
s_cmp_lg_u32 s50, -1
s_cbranch_scc1 G_NBL0
s_setprio 1
s_cmp_lg_u32 s49, -1
s_cbranch_scc1 G_NBL0
s_setprio 0
G_NBL0:
s_waitcnt vmcnt(4)
v_perm_b32 v96, v72, v64, s30
v_perm_b32 v97, v72, v64, s31
v_perm_b32 v98, v73, v65, s30
v_perm_b32 v99, v73, v65, s31
v_perm_b32 v100, v74, v66, s30
v_perm_b32 v101, v74, v66, s31
v_perm_b32 v102, v75, v67, s30
v_perm_b32 v103, v75, v67, s31
v_perm_b32 v104, v76, v68, s30
v_perm_b32 v105, v76, v68, s31
v_perm_b32 v106, v77, v69, s30
v_perm_b32 v107, v77, v69, s31
v_perm_b32 v108, v78, v70, s30
v_perm_b32 v109, v78, v70, s31
v_perm_b32 v110, v79, v71, s30
v_perm_b32 v111, v79, v71, s31
s_waitcnt lgkmcnt(0)
v_lshrrev_b32 v5, 9, v88
v_and_b32 v5, -32, v5
v_lshlrev_b32 v92, 3, v88
v_and_b32 v92, s54, v92
v_add_u32_dpp v6, v5, v14 quad_perm:[0,0,2,2] row_mask:0xf bank_mask:0xf
v_add_u32_dpp v7, v5, v14 quad_perm:[1,1,3,3] row_mask:0xf bank_mask:0xf
v_cmp_eq_u32 vcc, 0, v92
buffer_load_dwordx4 v[64:67], v6, s[16:19], 0 offen
buffer_load_dwordx4 v[68:71], v7, s[16:19], 0 offen
v_cndmask_b32 v92, v92, v93, vcc
v_cndmask_b32 v93, v93, v94, vcc
v_cndmask_b32 v94, v94, v95, vcc
v_cndmask_b32 v95, v95, 0, vcc
ds_read_b64 v[90:91], v92 offset:18240
v_dot2c_f32_bf16_dpp v16, v82, v96 quad_perm:[0,0,2,2] row_mask:0xf bank_mask:0xf
v_dot2c_f32_bf16_dpp v17, v82, v97 quad_perm:[0,0,2,2] row_mask:0xf bank_mask:0xf
v_dot2c_f32_bf16_dpp v18, v82, v98 quad_perm:[0,0,2,2] row_mask:0xf bank_mask:0xf
v_dot2c_f32_bf16_dpp v19, v82, v99 quad_perm:[0,0,2,2] row_mask:0xf bank_mask:0xf
v_dot2c_f32_bf16_dpp v20, v82, v100 quad_perm:[0,0,2,2] row_mask:0xf bank_mask:0xf
v_dot2c_f32_bf16_dpp v21, v82, v101 quad_perm:[0,0,2,2] row_mask:0xf bank_mask:0xf
v_dot2c_f32_bf16_dpp v22, v82, v102 quad_perm:[0,0,2,2] row_mask:0xf bank_mask:0xf
v_dot2c_f32_bf16_dpp v23, v82, v103 quad_perm:[0,0,2,2] row_mask:0xf bank_mask:0xf
v_dot2c_f32_bf16_dpp v32, v83, v96 quad_perm:[0,0,2,2] row_mask:0xf bank_mask:0xf
v_dot2c_f32_bf16_dpp v33, v83, v97 quad_perm:[0,0,2,2] row_mask:0xf bank_mask:0xf
v_dot2c_f32_bf16_dpp v34, v83, v98 quad_perm:[0,0,2,2] row_mask:0xf bank_mask:0xf
v_dot2c_f32_bf16_dpp v35, v83, v99 quad_perm:[0,0,2,2] row_mask:0xf bank_mask:0xf
v_dot2c_f32_bf16_dpp v36, v83, v100 quad_perm:[0,0,2,2] row_mask:0xf bank_mask:0xf
v_dot2c_f32_bf16_dpp v37, v83, v101 quad_perm:[0,0,2,2] row_mask:0xf bank_mask:0xf
v_dot2c_f32_bf16_dpp v38, v83, v102 quad_perm:[0,0,2,2] row_mask:0xf bank_mask:0xf
v_dot2c_f32_bf16_dpp v39, v83, v103 quad_perm:[0,0,2,2] row_mask:0xf bank_mask:0xf
s_waitcnt lgkmcnt(0)
v_lshrrev_b32 v5, 9, v90
v_and_b32 v5, -32, v5
v_lshlrev_b32 v92, 3, v90
v_and_b32 v92, s54, v92
v_add_u32_dpp v6, v5, v14 quad_perm:[0,0,2,2] row_mask:0xf bank_mask:0xf
v_add_u32_dpp v7, v5, v14 quad_perm:[1,1,3,3] row_mask:0xf bank_mask:0xf
v_cmp_eq_u32 vcc, 0, v92
buffer_load_dwordx4 v[72:75], v6, s[16:19], 0 offen
buffer_load_dwordx4 v[76:79], v7, s[16:19], 0 offen
v_cndmask_b32 v92, v92, v93, vcc
v_cndmask_b32 v93, v93, v94, vcc
v_cndmask_b32 v94, v94, v95, vcc
v_cndmask_b32 v95, v95, 0, vcc
ds_read_b64 v[84:85], v92 offset:18240
v_dot2c_f32_bf16_dpp v24, v82, v104 quad_perm:[1,1,3,3] row_mask:0xf bank_mask:0xf
v_dot2c_f32_bf16_dpp v25, v82, v105 quad_perm:[1,1,3,3] row_mask:0xf bank_mask:0xf
v_dot2c_f32_bf16_dpp v26, v82, v106 quad_perm:[1,1,3,3] row_mask:0xf bank_mask:0xf
v_dot2c_f32_bf16_dpp v27, v82, v107 quad_perm:[1,1,3,3] row_mask:0xf bank_mask:0xf
v_dot2c_f32_bf16_dpp v28, v82, v108 quad_perm:[1,1,3,3] row_mask:0xf bank_mask:0xf
v_dot2c_f32_bf16_dpp v29, v82, v109 quad_perm:[1,1,3,3] row_mask:0xf bank_mask:0xf
v_dot2c_f32_bf16_dpp v30, v82, v110 quad_perm:[1,1,3,3] row_mask:0xf bank_mask:0xf
v_dot2c_f32_bf16_dpp v31, v82, v111 quad_perm:[1,1,3,3] row_mask:0xf bank_mask:0xf
v_dot2c_f32_bf16_dpp v40, v83, v104 quad_perm:[1,1,3,3] row_mask:0xf bank_mask:0xf
v_dot2c_f32_bf16_dpp v41, v83, v105 quad_perm:[1,1,3,3] row_mask:0xf bank_mask:0xf
v_dot2c_f32_bf16_dpp v42, v83, v106 quad_perm:[1,1,3,3] row_mask:0xf bank_mask:0xf
v_dot2c_f32_bf16_dpp v43, v83, v107 quad_perm:[1,1,3,3] row_mask:0xf bank_mask:0xf
v_dot2c_f32_bf16_dpp v44, v83, v108 quad_perm:[1,1,3,3] row_mask:0xf bank_mask:0xf
v_dot2c_f32_bf16_dpp v45, v83, v109 quad_perm:[1,1,3,3] row_mask:0xf bank_mask:0xf
v_dot2c_f32_bf16_dpp v46, v83, v110 quad_perm:[1,1,3,3] row_mask:0xf bank_mask:0xf
v_dot2c_f32_bf16_dpp v47, v83, v111 quad_perm:[1,1,3,3] row_mask:0xf bank_mask:0xf
v_cmp_ne_u32 vcc, 0, v92
v_perm_b32 v82, v91, v89, s30
v_perm_b32 v83, v91, v89, s31
s_add_u32 s48, s48, 32
s_cbranch_vccz G_DRL2
s_cmp_lt_u32 s48, s49
s_cbranch_scc1 G_NBL2
s_mov_b32 s49, s50
s_mov_b32 s50, s51
s_mov_b32 s51, -1
s_setprio 2
s_cmp_lg_u32 s50, -1
s_cbranch_scc1 G_NBL2
s_setprio 1
s_cmp_lg_u32 s49, -1
s_cbranch_scc1 G_NBL2
s_setprio 0
G_NBL2:
s_sub_u32 s62, s62, 1
s_cbranch_scc0 G_LOOP
s_branch G_DRL2
G_DRP0:
s_waitcnt vmcnt(0)
v_perm_b32 v96, v56, v48, s30
v_perm_b32 v97, v56, v48, s31
v_perm_b32 v98, v57, v49, s30
v_perm_b32 v99, v57, v49, s31
v_perm_b32 v100, v58, v50, s30
v_perm_b32 v101, v58, v50, s31
v_perm_b32 v102, v59, v51, s30
v_perm_b32 v103, v59, v51, s31
v_perm_b32 v104, v60, v52, s30
v_perm_b32 v105, v60, v52, s31
v_perm_b32 v106, v61, v53, s30
v_perm_b32 v107, v61, v53, s31
v_perm_b32 v108, v62, v54, s30
v_perm_b32 v109, v62, v54, s31
v_perm_b32 v110, v63, v55, s30
v_perm_b32 v111, v63, v55, s31
v_dot2c_f32_bf16_dpp v16, v80, v96 quad_perm:[0,0,2,2] row_mask:0xf bank_mask:0xf
v_dot2c_f32_bf16_dpp v17, v80, v97 quad_perm:[0,0,2,2] row_mask:0xf bank_mask:0xf
v_dot2c_f32_bf16_dpp v18, v80, v98 quad_perm:[0,0,2,2] row_mask:0xf bank_mask:0xf
v_dot2c_f32_bf16_dpp v19, v80, v99 quad_perm:[0,0,2,2] row_mask:0xf bank_mask:0xf
v_dot2c_f32_bf16_dpp v20, v80, v100 quad_perm:[0,0,2,2] row_mask:0xf bank_mask:0xf
v_dot2c_f32_bf16_dpp v21, v80, v101 quad_perm:[0,0,2,2] row_mask:0xf bank_mask:0xf
v_dot2c_f32_bf16_dpp v22, v80, v102 quad_perm:[0,0,2,2] row_mask:0xf bank_mask:0xf
v_dot2c_f32_bf16_dpp v23, v80, v103 quad_perm:[0,0,2,2] row_mask:0xf bank_mask:0xf
v_dot2c_f32_bf16_dpp v32, v81, v96 quad_perm:[0,0,2,2] row_mask:0xf bank_mask:0xf
v_dot2c_f32_bf16_dpp v33, v81, v97 quad_perm:[0,0,2,2] row_mask:0xf bank_mask:0xf
v_dot2c_f32_bf16_dpp v34, v81, v98 quad_perm:[0,0,2,2] row_mask:0xf bank_mask:0xf
v_dot2c_f32_bf16_dpp v35, v81, v99 quad_perm:[0,0,2,2] row_mask:0xf bank_mask:0xf
v_dot2c_f32_bf16_dpp v36, v81, v100 quad_perm:[0,0,2,2] row_mask:0xf bank_mask:0xf
v_dot2c_f32_bf16_dpp v37, v81, v101 quad_perm:[0,0,2,2] row_mask:0xf bank_mask:0xf
v_dot2c_f32_bf16_dpp v38, v81, v102 quad_perm:[0,0,2,2] row_mask:0xf bank_mask:0xf
v_dot2c_f32_bf16_dpp v39, v81, v103 quad_perm:[0,0,2,2] row_mask:0xf bank_mask:0xf
v_dot2c_f32_bf16_dpp v24, v80, v104 quad_perm:[1,1,3,3] row_mask:0xf bank_mask:0xf
v_dot2c_f32_bf16_dpp v25, v80, v105 quad_perm:[1,1,3,3] row_mask:0xf bank_mask:0xf
v_dot2c_f32_bf16_dpp v26, v80, v106 quad_perm:[1,1,3,3] row_mask:0xf bank_mask:0xf
v_dot2c_f32_bf16_dpp v27, v80, v107 quad_perm:[1,1,3,3] row_mask:0xf bank_mask:0xf
v_dot2c_f32_bf16_dpp v28, v80, v108 quad_perm:[1,1,3,3] row_mask:0xf bank_mask:0xf
v_dot2c_f32_bf16_dpp v29, v80, v109 quad_perm:[1,1,3,3] row_mask:0xf bank_mask:0xf
v_dot2c_f32_bf16_dpp v30, v80, v110 quad_perm:[1,1,3,3] row_mask:0xf bank_mask:0xf
v_dot2c_f32_bf16_dpp v31, v80, v111 quad_perm:[1,1,3,3] row_mask:0xf bank_mask:0xf
v_dot2c_f32_bf16_dpp v40, v81, v104 quad_perm:[1,1,3,3] row_mask:0xf bank_mask:0xf
v_dot2c_f32_bf16_dpp v41, v81, v105 quad_perm:[1,1,3,3] row_mask:0xf bank_mask:0xf
v_dot2c_f32_bf16_dpp v42, v81, v106 quad_perm:[1,1,3,3] row_mask:0xf bank_mask:0xf
v_dot2c_f32_bf16_dpp v43, v81, v107 quad_perm:[1,1,3,3] row_mask:0xf bank_mask:0xf
v_dot2c_f32_bf16_dpp v44, v81, v108 quad_perm:[1,1,3,3] row_mask:0xf bank_mask:0xf
v_dot2c_f32_bf16_dpp v45, v81, v109 quad_perm:[1,1,3,3] row_mask:0xf bank_mask:0xf
v_dot2c_f32_bf16_dpp v46, v81, v110 quad_perm:[1,1,3,3] row_mask:0xf bank_mask:0xf
v_dot2c_f32_bf16_dpp v47, v81, v111 quad_perm:[1,1,3,3] row_mask:0xf bank_mask:0xf
s_branch G_DONE
G_DRP2:
G_DRL2:
s_waitcnt vmcnt(4)
v_perm_b32 v96, v56, v48, s30
v_perm_b32 v97, v56, v48, s31
v_perm_b32 v98, v57, v49, s30
v_perm_b32 v99, v57, v49, s31
v_perm_b32 v100, v58, v50, s30
v_perm_b32 v101, v58, v50, s31
v_perm_b32 v102, v59, v51, s30
v_perm_b32 v103, v59, v51, s31
v_perm_b32 v104, v60, v52, s30
v_perm_b32 v105, v60, v52, s31
v_perm_b32 v106, v61, v53, s30
v_perm_b32 v107, v61, v53, s31
v_perm_b32 v108, v62, v54, s30
v_perm_b32 v109, v62, v54, s31
v_perm_b32 v110, v63, v55, s30
v_perm_b32 v111, v63, v55, s31
v_dot2c_f32_bf16_dpp v16, v80, v96 quad_perm:[0,0,2,2] row_mask:0xf bank_mask:0xf
v_dot2c_f32_bf16_dpp v17, v80, v97 quad_perm:[0,0,2,2] row_mask:0xf bank_mask:0xf
v_dot2c_f32_bf16_dpp v18, v80, v98 quad_perm:[0,0,2,2] row_mask:0xf bank_mask:0xf
v_dot2c_f32_bf16_dpp v19, v80, v99 quad_perm:[0,0,2,2] row_mask:0xf bank_mask:0xf
v_dot2c_f32_bf16_dpp v20, v80, v100 quad_perm:[0,0,2,2] row_mask:0xf bank_mask:0xf
v_dot2c_f32_bf16_dpp v21, v80, v101 quad_perm:[0,0,2,2] row_mask:0xf bank_mask:0xf
v_dot2c_f32_bf16_dpp v22, v80, v102 quad_perm:[0,0,2,2] row_mask:0xf bank_mask:0xf
v_dot2c_f32_bf16_dpp v23, v80, v103 quad_perm:[0,0,2,2] row_mask:0xf bank_mask:0xf
v_dot2c_f32_bf16_dpp v32, v81, v96 quad_perm:[0,0,2,2] row_mask:0xf bank_mask:0xf
v_dot2c_f32_bf16_dpp v33, v81, v97 quad_perm:[0,0,2,2] row_mask:0xf bank_mask:0xf
v_dot2c_f32_bf16_dpp v34, v81, v98 quad_perm:[0,0,2,2] row_mask:0xf bank_mask:0xf
v_dot2c_f32_bf16_dpp v35, v81, v99 quad_perm:[0,0,2,2] row_mask:0xf bank_mask:0xf
v_dot2c_f32_bf16_dpp v36, v81, v100 quad_perm:[0,0,2,2] row_mask:0xf bank_mask:0xf
v_dot2c_f32_bf16_dpp v37, v81, v101 quad_perm:[0,0,2,2] row_mask:0xf bank_mask:0xf
v_dot2c_f32_bf16_dpp v38, v81, v102 quad_perm:[0,0,2,2] row_mask:0xf bank_mask:0xf
v_dot2c_f32_bf16_dpp v39, v81, v103 quad_perm:[0,0,2,2] row_mask:0xf bank_mask:0xf
v_dot2c_f32_bf16_dpp v24, v80, v104 quad_perm:[1,1,3,3] row_mask:0xf bank_mask:0xf
v_dot2c_f32_bf16_dpp v25, v80, v105 quad_perm:[1,1,3,3] row_mask:0xf bank_mask:0xf
v_dot2c_f32_bf16_dpp v26, v80, v106 quad_perm:[1,1,3,3] row_mask:0xf bank_mask:0xf
v_dot2c_f32_bf16_dpp v27, v80, v107 quad_perm:[1,1,3,3] row_mask:0xf bank_mask:0xf
v_dot2c_f32_bf16_dpp v28, v80, v108 quad_perm:[1,1,3,3] row_mask:0xf bank_mask:0xf
v_dot2c_f32_bf16_dpp v29, v80, v109 quad_perm:[1,1,3,3] row_mask:0xf bank_mask:0xf
v_dot2c_f32_bf16_dpp v30, v80, v110 quad_perm:[1,1,3,3] row_mask:0xf bank_mask:0xf
v_dot2c_f32_bf16_dpp v31, v80, v111 quad_perm:[1,1,3,3] row_mask:0xf bank_mask:0xf
v_dot2c_f32_bf16_dpp v40, v81, v104 quad_perm:[1,1,3,3] row_mask:0xf bank_mask:0xf
v_dot2c_f32_bf16_dpp v41, v81, v105 quad_perm:[1,1,3,3] row_mask:0xf bank_mask:0xf
v_dot2c_f32_bf16_dpp v42, v81, v106 quad_perm:[1,1,3,3] row_mask:0xf bank_mask:0xf
v_dot2c_f32_bf16_dpp v43, v81, v107 quad_perm:[1,1,3,3] row_mask:0xf bank_mask:0xf
v_dot2c_f32_bf16_dpp v44, v81, v108 quad_perm:[1,1,3,3] row_mask:0xf bank_mask:0xf
v_dot2c_f32_bf16_dpp v45, v81, v109 quad_perm:[1,1,3,3] row_mask:0xf bank_mask:0xf
v_dot2c_f32_bf16_dpp v46, v81, v110 quad_perm:[1,1,3,3] row_mask:0xf bank_mask:0xf
v_dot2c_f32_bf16_dpp v47, v81, v111 quad_perm:[1,1,3,3] row_mask:0xf bank_mask:0xf
s_waitcnt vmcnt(0)
v_perm_b32 v96, v72, v64, s30
v_perm_b32 v97, v72, v64, s31
v_perm_b32 v98, v73, v65, s30
v_perm_b32 v99, v73, v65, s31
v_perm_b32 v100, v74, v66, s30
v_perm_b32 v101, v74, v66, s31
v_perm_b32 v102, v75, v67, s30
v_perm_b32 v103, v75, v67, s31
v_perm_b32 v104, v76, v68, s30
v_perm_b32 v105, v76, v68, s31
v_perm_b32 v106, v77, v69, s30
v_perm_b32 v107, v77, v69, s31
v_perm_b32 v108, v78, v70, s30
v_perm_b32 v109, v78, v70, s31
v_perm_b32 v110, v79, v71, s30
v_perm_b32 v111, v79, v71, s31
v_dot2c_f32_bf16_dpp v16, v82, v96 quad_perm:[0,0,2,2] row_mask:0xf bank_mask:0xf
v_dot2c_f32_bf16_dpp v17, v82, v97 quad_perm:[0,0,2,2] row_mask:0xf bank_mask:0xf
v_dot2c_f32_bf16_dpp v18, v82, v98 quad_perm:[0,0,2,2] row_mask:0xf bank_mask:0xf
v_dot2c_f32_bf16_dpp v19, v82, v99 quad_perm:[0,0,2,2] row_mask:0xf bank_mask:0xf
v_dot2c_f32_bf16_dpp v20, v82, v100 quad_perm:[0,0,2,2] row_mask:0xf bank_mask:0xf
v_dot2c_f32_bf16_dpp v21, v82, v101 quad_perm:[0,0,2,2] row_mask:0xf bank_mask:0xf
v_dot2c_f32_bf16_dpp v22, v82, v102 quad_perm:[0,0,2,2] row_mask:0xf bank_mask:0xf
v_dot2c_f32_bf16_dpp v23, v82, v103 quad_perm:[0,0,2,2] row_mask:0xf bank_mask:0xf
v_dot2c_f32_bf16_dpp v32, v83, v96 quad_perm:[0,0,2,2] row_mask:0xf bank_mask:0xf
v_dot2c_f32_bf16_dpp v33, v83, v97 quad_perm:[0,0,2,2] row_mask:0xf bank_mask:0xf
v_dot2c_f32_bf16_dpp v34, v83, v98 quad_perm:[0,0,2,2] row_mask:0xf bank_mask:0xf
v_dot2c_f32_bf16_dpp v35, v83, v99 quad_perm:[0,0,2,2] row_mask:0xf bank_mask:0xf
v_dot2c_f32_bf16_dpp v36, v83, v100 quad_perm:[0,0,2,2] row_mask:0xf bank_mask:0xf
v_dot2c_f32_bf16_dpp v37, v83, v101 quad_perm:[0,0,2,2] row_mask:0xf bank_mask:0xf
v_dot2c_f32_bf16_dpp v38, v83, v102 quad_perm:[0,0,2,2] row_mask:0xf bank_mask:0xf
v_dot2c_f32_bf16_dpp v39, v83, v103 quad_perm:[0,0,2,2] row_mask:0xf bank_mask:0xf
v_dot2c_f32_bf16_dpp v24, v82, v104 quad_perm:[1,1,3,3] row_mask:0xf bank_mask:0xf
v_dot2c_f32_bf16_dpp v25, v82, v105 quad_perm:[1,1,3,3] row_mask:0xf bank_mask:0xf
v_dot2c_f32_bf16_dpp v26, v82, v106 quad_perm:[1,1,3,3] row_mask:0xf bank_mask:0xf
v_dot2c_f32_bf16_dpp v27, v82, v107 quad_perm:[1,1,3,3] row_mask:0xf bank_mask:0xf
v_dot2c_f32_bf16_dpp v28, v82, v108 quad_perm:[1,1,3,3] row_mask:0xf bank_mask:0xf
v_dot2c_f32_bf16_dpp v29, v82, v109 quad_perm:[1,1,3,3] row_mask:0xf bank_mask:0xf
v_dot2c_f32_bf16_dpp v30, v82, v110 quad_perm:[1,1,3,3] row_mask:0xf bank_mask:0xf
v_dot2c_f32_bf16_dpp v31, v82, v111 quad_perm:[1,1,3,3] row_mask:0xf bank_mask:0xf
v_dot2c_f32_bf16_dpp v40, v83, v104 quad_perm:[1,1,3,3] row_mask:0xf bank_mask:0xf
v_dot2c_f32_bf16_dpp v41, v83, v105 quad_perm:[1,1,3,3] row_mask:0xf bank_mask:0xf
v_dot2c_f32_bf16_dpp v42, v83, v106 quad_perm:[1,1,3,3] row_mask:0xf bank_mask:0xf
v_dot2c_f32_bf16_dpp v43, v83, v107 quad_perm:[1,1,3,3] row_mask:0xf bank_mask:0xf
v_dot2c_f32_bf16_dpp v44, v83, v108 quad_perm:[1,1,3,3] row_mask:0xf bank_mask:0xf
v_dot2c_f32_bf16_dpp v45, v83, v109 quad_perm:[1,1,3,3] row_mask:0xf bank_mask:0xf
v_dot2c_f32_bf16_dpp v46, v83, v110 quad_perm:[1,1,3,3] row_mask:0xf bank_mask:0xf
v_dot2c_f32_bf16_dpp v47, v83, v111 quad_perm:[1,1,3,3] row_mask:0xf bank_mask:0xf
s_branch G_DONE
G_DRL0:
s_waitcnt vmcnt(4)
v_perm_b32 v96, v72, v64, s30
v_perm_b32 v97, v72, v64, s31
v_perm_b32 v98, v73, v65, s30
v_perm_b32 v99, v73, v65, s31
v_perm_b32 v100, v74, v66, s30
v_perm_b32 v101, v74, v66, s31
v_perm_b32 v102, v75, v67, s30
v_perm_b32 v103, v75, v67, s31
v_perm_b32 v104, v76, v68, s30
v_perm_b32 v105, v76, v68, s31
v_perm_b32 v106, v77, v69, s30
v_perm_b32 v107, v77, v69, s31
v_perm_b32 v108, v78, v70, s30
v_perm_b32 v109, v78, v70, s31
v_perm_b32 v110, v79, v71, s30
v_perm_b32 v111, v79, v71, s31
v_dot2c_f32_bf16_dpp v16, v82, v96 quad_perm:[0,0,2,2] row_mask:0xf bank_mask:0xf
v_dot2c_f32_bf16_dpp v17, v82, v97 quad_perm:[0,0,2,2] row_mask:0xf bank_mask:0xf
v_dot2c_f32_bf16_dpp v18, v82, v98 quad_perm:[0,0,2,2] row_mask:0xf bank_mask:0xf
v_dot2c_f32_bf16_dpp v19, v82, v99 quad_perm:[0,0,2,2] row_mask:0xf bank_mask:0xf
v_dot2c_f32_bf16_dpp v20, v82, v100 quad_perm:[0,0,2,2] row_mask:0xf bank_mask:0xf
v_dot2c_f32_bf16_dpp v21, v82, v101 quad_perm:[0,0,2,2] row_mask:0xf bank_mask:0xf
v_dot2c_f32_bf16_dpp v22, v82, v102 quad_perm:[0,0,2,2] row_mask:0xf bank_mask:0xf
v_dot2c_f32_bf16_dpp v23, v82, v103 quad_perm:[0,0,2,2] row_mask:0xf bank_mask:0xf
v_dot2c_f32_bf16_dpp v32, v83, v96 quad_perm:[0,0,2,2] row_mask:0xf bank_mask:0xf
v_dot2c_f32_bf16_dpp v33, v83, v97 quad_perm:[0,0,2,2] row_mask:0xf bank_mask:0xf
v_dot2c_f32_bf16_dpp v34, v83, v98 quad_perm:[0,0,2,2] row_mask:0xf bank_mask:0xf
v_dot2c_f32_bf16_dpp v35, v83, v99 quad_perm:[0,0,2,2] row_mask:0xf bank_mask:0xf
v_dot2c_f32_bf16_dpp v36, v83, v100 quad_perm:[0,0,2,2] row_mask:0xf bank_mask:0xf
v_dot2c_f32_bf16_dpp v37, v83, v101 quad_perm:[0,0,2,2] row_mask:0xf bank_mask:0xf
v_dot2c_f32_bf16_dpp v38, v83, v102 quad_perm:[0,0,2,2] row_mask:0xf bank_mask:0xf
v_dot2c_f32_bf16_dpp v39, v83, v103 quad_perm:[0,0,2,2] row_mask:0xf bank_mask:0xf
v_dot2c_f32_bf16_dpp v24, v82, v104 quad_perm:[1,1,3,3] row_mask:0xf bank_mask:0xf
v_dot2c_f32_bf16_dpp v25, v82, v105 quad_perm:[1,1,3,3] row_mask:0xf bank_mask:0xf
v_dot2c_f32_bf16_dpp v26, v82, v106 quad_perm:[1,1,3,3] row_mask:0xf bank_mask:0xf
v_dot2c_f32_bf16_dpp v27, v82, v107 quad_perm:[1,1,3,3] row_mask:0xf bank_mask:0xf
v_dot2c_f32_bf16_dpp v28, v82, v108 quad_perm:[1,1,3,3] row_mask:0xf bank_mask:0xf
v_dot2c_f32_bf16_dpp v29, v82, v109 quad_perm:[1,1,3,3] row_mask:0xf bank_mask:0xf
v_dot2c_f32_bf16_dpp v30, v82, v110 quad_perm:[1,1,3,3] row_mask:0xf bank_mask:0xf
v_dot2c_f32_bf16_dpp v31, v82, v111 quad_perm:[1,1,3,3] row_mask:0xf bank_mask:0xf
v_dot2c_f32_bf16_dpp v40, v83, v104 quad_perm:[1,1,3,3] row_mask:0xf bank_mask:0xf
v_dot2c_f32_bf16_dpp v41, v83, v105 quad_perm:[1,1,3,3] row_mask:0xf bank_mask:0xf
v_dot2c_f32_bf16_dpp v42, v83, v106 quad_perm:[1,1,3,3] row_mask:0xf bank_mask:0xf
v_dot2c_f32_bf16_dpp v43, v83, v107 quad_perm:[1,1,3,3] row_mask:0xf bank_mask:0xf
v_dot2c_f32_bf16_dpp v44, v83, v108 quad_perm:[1,1,3,3] row_mask:0xf bank_mask:0xf
v_dot2c_f32_bf16_dpp v45, v83, v109 quad_perm:[1,1,3,3] row_mask:0xf bank_mask:0xf
v_dot2c_f32_bf16_dpp v46, v83, v110 quad_perm:[1,1,3,3] row_mask:0xf bank_mask:0xf
v_dot2c_f32_bf16_dpp v47, v83, v111 quad_perm:[1,1,3,3] row_mask:0xf bank_mask:0xf
s_waitcnt vmcnt(0)
v_perm_b32 v96, v56, v48, s30
v_perm_b32 v97, v56, v48, s31
v_perm_b32 v98, v57, v49, s30
v_perm_b32 v99, v57, v49, s31
v_perm_b32 v100, v58, v50, s30
v_perm_b32 v101, v58, v50, s31
v_perm_b32 v102, v59, v51, s30
v_perm_b32 v103, v59, v51, s31
v_perm_b32 v104, v60, v52, s30
v_perm_b32 v105, v60, v52, s31
v_perm_b32 v106, v61, v53, s30
v_perm_b32 v107, v61, v53, s31
v_perm_b32 v108, v62, v54, s30
v_perm_b32 v109, v62, v54, s31
v_perm_b32 v110, v63, v55, s30
v_perm_b32 v111, v63, v55, s31
v_dot2c_f32_bf16_dpp v16, v80, v96 quad_perm:[0,0,2,2] row_mask:0xf bank_mask:0xf
v_dot2c_f32_bf16_dpp v17, v80, v97 quad_perm:[0,0,2,2] row_mask:0xf bank_mask:0xf
v_dot2c_f32_bf16_dpp v18, v80, v98 quad_perm:[0,0,2,2] row_mask:0xf bank_mask:0xf
v_dot2c_f32_bf16_dpp v19, v80, v99 quad_perm:[0,0,2,2] row_mask:0xf bank_mask:0xf
v_dot2c_f32_bf16_dpp v20, v80, v100 quad_perm:[0,0,2,2] row_mask:0xf bank_mask:0xf
v_dot2c_f32_bf16_dpp v21, v80, v101 quad_perm:[0,0,2,2] row_mask:0xf bank_mask:0xf
v_dot2c_f32_bf16_dpp v22, v80, v102 quad_perm:[0,0,2,2] row_mask:0xf bank_mask:0xf
v_dot2c_f32_bf16_dpp v23, v80, v103 quad_perm:[0,0,2,2] row_mask:0xf bank_mask:0xf
v_dot2c_f32_bf16_dpp v32, v81, v96 quad_perm:[0,0,2,2] row_mask:0xf bank_mask:0xf
v_dot2c_f32_bf16_dpp v33, v81, v97 quad_perm:[0,0,2,2] row_mask:0xf bank_mask:0xf
v_dot2c_f32_bf16_dpp v34, v81, v98 quad_perm:[0,0,2,2] row_mask:0xf bank_mask:0xf
v_dot2c_f32_bf16_dpp v35, v81, v99 quad_perm:[0,0,2,2] row_mask:0xf bank_mask:0xf
v_dot2c_f32_bf16_dpp v36, v81, v100 quad_perm:[0,0,2,2] row_mask:0xf bank_mask:0xf
v_dot2c_f32_bf16_dpp v37, v81, v101 quad_perm:[0,0,2,2] row_mask:0xf bank_mask:0xf
v_dot2c_f32_bf16_dpp v38, v81, v102 quad_perm:[0,0,2,2] row_mask:0xf bank_mask:0xf
v_dot2c_f32_bf16_dpp v39, v81, v103 quad_perm:[0,0,2,2] row_mask:0xf bank_mask:0xf
v_dot2c_f32_bf16_dpp v24, v80, v104 quad_perm:[1,1,3,3] row_mask:0xf bank_mask:0xf
v_dot2c_f32_bf16_dpp v25, v80, v105 quad_perm:[1,1,3,3] row_mask:0xf bank_mask:0xf
v_dot2c_f32_bf16_dpp v26, v80, v106 quad_perm:[1,1,3,3] row_mask:0xf bank_mask:0xf
v_dot2c_f32_bf16_dpp v27, v80, v107 quad_perm:[1,1,3,3] row_mask:0xf bank_mask:0xf
v_dot2c_f32_bf16_dpp v28, v80, v108 quad_perm:[1,1,3,3] row_mask:0xf bank_mask:0xf
v_dot2c_f32_bf16_dpp v29, v80, v109 quad_perm:[1,1,3,3] row_mask:0xf bank_mask:0xf
v_dot2c_f32_bf16_dpp v30, v80, v110 quad_perm:[1,1,3,3] row_mask:0xf bank_mask:0xf
v_dot2c_f32_bf16_dpp v31, v80, v111 quad_perm:[1,1,3,3] row_mask:0xf bank_mask:0xf
v_dot2c_f32_bf16_dpp v40, v81, v104 quad_perm:[1,1,3,3] row_mask:0xf bank_mask:0xf
v_dot2c_f32_bf16_dpp v41, v81, v105 quad_perm:[1,1,3,3] row_mask:0xf bank_mask:0xf
v_dot2c_f32_bf16_dpp v42, v81, v106 quad_perm:[1,1,3,3] row_mask:0xf bank_mask:0xf
v_dot2c_f32_bf16_dpp v43, v81, v107 quad_perm:[1,1,3,3] row_mask:0xf bank_mask:0xf
v_dot2c_f32_bf16_dpp v44, v81, v108 quad_perm:[1,1,3,3] row_mask:0xf bank_mask:0xf
v_dot2c_f32_bf16_dpp v45, v81, v109 quad_perm:[1,1,3,3] row_mask:0xf bank_mask:0xf
v_dot2c_f32_bf16_dpp v46, v81, v110 quad_perm:[1,1,3,3] row_mask:0xf bank_mask:0xf
v_dot2c_f32_bf16_dpp v47, v81, v111 quad_perm:[1,1,3,3] row_mask:0xf bank_mask:0xf
s_branch G_DONE
G_DONE:
s_nop 2
s_waitcnt lgkmcnt(0)
s_cmp_le_u32 s56, s44
s_cbranch_scc1 G_EPI
s_add_u32 s44, s44, 1
s_waitcnt lgkmcnt(0)
s_barrier
v_lshlrev_b32 v5, 4, v0
v_mov_b32 v8, 0
v_mov_b32 v9, 0
v_mov_b32 v10, 0
v_mov_b32 v11, 0
ds_write_b32 v13, v8
ds_write_b128 v5, v[8:11]
v_lshlrev_b32 v5, 2, v0
ds_write_b32 v5, v8 offset:12848
ds_write_b32 v5, v8 offset:15408
s_waitcnt lgkmcnt(0)
s_barrier
s_branch G_ROUND
G_EPI:
v_cvt_pk_bf16_f32 v56, v16, v17
v_cvt_pk_bf16_f32 v57, v18, v19
v_cvt_pk_bf16_f32 v58, v20, v21
v_cvt_pk_bf16_f32 v59, v22, v23
v_cvt_pk_bf16_f32 v60, v24, v25
v_cvt_pk_bf16_f32 v61, v26, v27
v_cvt_pk_bf16_f32 v62, v28, v29
v_cvt_pk_bf16_f32 v63, v30, v31
v_cvt_pk_bf16_f32 v64, v32, v33
v_cvt_pk_bf16_f32 v65, v34, v35
v_cvt_pk_bf16_f32 v66, v36, v37
v_cvt_pk_bf16_f32 v67, v38, v39
v_cvt_pk_bf16_f32 v68, v40, v41
v_cvt_pk_bf16_f32 v69, v42, v43
v_cvt_pk_bf16_f32 v70, v44, v45
v_cvt_pk_bf16_f32 v71, v46, v47
s_mov_b32 vcc_lo, 0x55555555
s_mov_b32 vcc_hi, 0x55555555
v_cndmask_b32_dpp v16, v60, v56, vcc quad_perm:[1,0,3,2] row_mask:0xf bank_mask:0xf
v_cndmask_b32_dpp v17, v61, v57, vcc quad_perm:[1,0,3,2] row_mask:0xf bank_mask:0xf
v_cndmask_b32_dpp v18, v62, v58, vcc quad_perm:[1,0,3,2] row_mask:0xf bank_mask:0xf
v_cndmask_b32_dpp v19, v63, v59, vcc quad_perm:[1,0,3,2] row_mask:0xf bank_mask:0xf
v_cndmask_b32_dpp v24, v68, v64, vcc quad_perm:[1,0,3,2] row_mask:0xf bank_mask:0xf
v_cndmask_b32_dpp v25, v69, v65, vcc quad_perm:[1,0,3,2] row_mask:0xf bank_mask:0xf
v_cndmask_b32_dpp v26, v70, v66, vcc quad_perm:[1,0,3,2] row_mask:0xf bank_mask:0xf
v_cndmask_b32_dpp v27, v71, v67, vcc quad_perm:[1,0,3,2] row_mask:0xf bank_mask:0xf
s_not_b64 vcc, vcc
v_cndmask_b32_dpp v20, v56, v60, vcc quad_perm:[1,0,3,2] row_mask:0xf bank_mask:0xf
v_cndmask_b32_dpp v21, v57, v61, vcc quad_perm:[1,0,3,2] row_mask:0xf bank_mask:0xf
v_cndmask_b32_dpp v22, v58, v62, vcc quad_perm:[1,0,3,2] row_mask:0xf bank_mask:0xf
v_cndmask_b32_dpp v23, v59, v63, vcc quad_perm:[1,0,3,2] row_mask:0xf bank_mask:0xf
v_cndmask_b32_dpp v28, v64, v68, vcc quad_perm:[1,0,3,2] row_mask:0xf bank_mask:0xf
v_cndmask_b32_dpp v29, v65, v69, vcc quad_perm:[1,0,3,2] row_mask:0xf bank_mask:0xf
v_cndmask_b32_dpp v30, v66, v70, vcc quad_perm:[1,0,3,2] row_mask:0xf bank_mask:0xf
v_cndmask_b32_dpp v31, v67, v71, vcc quad_perm:[1,0,3,2] row_mask:0xf bank_mask:0xf
s_nop 1
v_permlane32_swap_b32 v16, v20
v_permlane32_swap_b32 v17, v21
v_permlane32_swap_b32 v18, v22
v_permlane32_swap_b32 v19, v23
v_permlane32_swap_b32 v24, v28
v_permlane32_swap_b32 v25, v29
v_permlane32_swap_b32 v26, v30
v_permlane32_swap_b32 v27, v31
s_nop 1
v_mfma_f32_32x32x16_bf16 v[72:87], v[120:123], v[16:19], 0
v_mfma_f32_32x32x16_bf16 v[88:103], v[128:131], v[150:153], 0
v_mfma_f32_32x32x16_bf16 v[72:87], v[124:127], v[24:27], v[72:87]
v_mfma_f32_32x32x16_bf16 v[32:47], v[136:139], v[150:153], 0
s_nop 11
v_pk_mul_f32 v[88:89], v[88:89], v[72:73]
v_pk_mul_f32 v[90:91], v[90:91], v[74:75]
v_pk_mul_f32 v[92:93], v[92:93], v[76:77]
v_pk_mul_f32 v[94:95], v[94:95], v[78:79]
v_pk_fma_f32 v[88:89], v[96:97], v[80:81], v[88:89]
v_pk_fma_f32 v[90:91], v[98:99], v[82:83], v[90:91]
v_pk_fma_f32 v[92:93], v[100:101], v[84:85], v[92:93]
v_pk_fma_f32 v[94:95], v[102:103], v[86:87], v[94:95]
v_cvt_pk_bf16_f32 v72, v88, v89
v_cvt_pk_bf16_f32 v73, v90, v91
v_cvt_pk_bf16_f32 v74, v92, v93
v_cvt_pk_bf16_f32 v75, v94, v95
s_nop 1
v_mfma_f32_32x32x16_bf16 v[32:47], v[132:135], v[72:75], v[32:47]
v_lshlrev_b32 v88, 16, v140
v_and_b32 v89, s52, v140
v_lshlrev_b32 v90, 16, v141
v_and_b32 v91, s52, v141
v_lshlrev_b32 v92, 16, v142
v_and_b32 v93, s52, v142
v_lshlrev_b32 v94, 16, v143
v_and_b32 v95, s52, v143
s_nop 7
v_pk_fma_f32 v[88:89], v[32:33], v[40:41], v[88:89]
v_pk_fma_f32 v[90:91], v[34:35], v[42:43], v[90:91]
v_pk_fma_f32 v[92:93], v[36:37], v[44:45], v[92:93]
v_pk_fma_f32 v[94:95], v[38:39], v[46:47], v[94:95]
v_cvt_pk_bf16_f32 v140, v88, v89
v_cvt_pk_bf16_f32 v141, v90, v91
v_cvt_pk_bf16_f32 v142, v92, v93
v_cvt_pk_bf16_f32 v143, v94, v95
buffer_store_dwordx4 v[140:143], v148, s[32:35], s39 offen
s_nop 1
v_mfma_f32_32x32x16_bf16 v[72:87], v[120:123], v[20:23], 0
v_mfma_f32_32x32x16_bf16 v[88:103], v[128:131], v[154:157], 0
v_mfma_f32_32x32x16_bf16 v[72:87], v[124:127], v[28:31], v[72:87]
v_mfma_f32_32x32x16_bf16 v[32:47], v[136:139], v[154:157], 0
s_nop 11
v_pk_mul_f32 v[88:89], v[88:89], v[72:73]
v_pk_mul_f32 v[90:91], v[90:91], v[74:75]
v_pk_mul_f32 v[92:93], v[92:93], v[76:77]
v_pk_mul_f32 v[94:95], v[94:95], v[78:79]
v_pk_fma_f32 v[88:89], v[96:97], v[80:81], v[88:89]
v_pk_fma_f32 v[90:91], v[98:99], v[82:83], v[90:91]
v_pk_fma_f32 v[92:93], v[100:101], v[84:85], v[92:93]
v_pk_fma_f32 v[94:95], v[102:103], v[86:87], v[94:95]
v_cvt_pk_bf16_f32 v72, v88, v89
v_cvt_pk_bf16_f32 v73, v90, v91
v_cvt_pk_bf16_f32 v74, v92, v93
v_cvt_pk_bf16_f32 v75, v94, v95
s_nop 1
v_mfma_f32_32x32x16_bf16 v[32:47], v[132:135], v[72:75], v[32:47]
v_lshlrev_b32 v88, 16, v144
v_and_b32 v89, s52, v144
v_lshlrev_b32 v90, 16, v145
v_and_b32 v91, s52, v145
v_lshlrev_b32 v92, 16, v146
v_and_b32 v93, s52, v146
v_lshlrev_b32 v94, 16, v147
v_and_b32 v95, s52, v147
s_nop 7
v_pk_fma_f32 v[88:89], v[32:33], v[40:41], v[88:89]
v_pk_fma_f32 v[90:91], v[34:35], v[42:43], v[90:91]
v_pk_fma_f32 v[92:93], v[36:37], v[44:45], v[92:93]
v_pk_fma_f32 v[94:95], v[38:39], v[46:47], v[94:95]
v_cvt_pk_bf16_f32 v144, v88, v89
v_cvt_pk_bf16_f32 v145, v90, v91
v_cvt_pk_bf16_f32 v146, v92, v93
v_cvt_pk_bf16_f32 v147, v94, v95
buffer_store_dwordx4 v[144:147], v149, s[32:35], s39 offen
G_EXIT:
s_endpgm
.section .rodata,"a"
.p2align 6
.amdhsa_kernel part_kernel
  .amdhsa_next_free_vgpr 140
  .amdhsa_next_free_sgpr 80
  .amdhsa_accum_offset 140
  .amdhsa_group_segment_fixed_size 0
  .amdhsa_kernarg_size 112
  .amdhsa_user_sgpr_count 2
  .amdhsa_user_sgpr_kernarg_segment_ptr 1
  .amdhsa_system_sgpr_workgroup_id_x 1
.end_amdhsa_kernel
.p2align 6
.amdhsa_kernel gath_kernel
  .amdhsa_next_free_vgpr 160
  .amdhsa_next_free_sgpr 80
  .amdhsa_accum_offset 160
  .amdhsa_group_segment_fixed_size 0
  .amdhsa_kernarg_size 112
  .amdhsa_user_sgpr_count 2
  .amdhsa_user_sgpr_kernarg_segment_ptr 1
  .amdhsa_system_sgpr_workgroup_id_x 1
.end_amdhsa_kernel
```
